```python
import torch

def _softmax(x, axis=-1):
    return torch.softmax(x, dim=axis)

def _gelu(x):
    return torch.nn.functional.gelu(x, approximate='tanh')

def _silu(x):
    return torch.nn.functional.silu(x)

def _sigmoid(x):
    return torch.sigmoid(x)

def _layernorm(x, axis=-1, eps=1e-05):
    m = x.mean(dim=axis, keepdim=True)
    v = x.var(dim=axis, keepdim=True, unbiased=False)
    return (x - m) / torch.sqrt(v + eps)

def _scatter_add(tgt, idx, src, axis=0):
    return tgt.clone().index_add_(axis, idx, src)

def _segment_sum(src, seg, n):
    out = torch.zeros((n,) + src.shape[1:], dtype=src.dtype)
    return out.index_add_(0, seg, src)

def _pad(x, pw):
    flat = tuple((v for pair in reversed(pw) for v in pair))
    return torch.nn.functional.pad(x, flat)
kernel_name = 'adaLN_cond__ssm_conv_h3__glu_gated_swiglu__prompt'

def setup_inputs():

    _w = lambda a: (lambda t: t.to(torch.bfloat16) if t.is_floating_point() else t)(torch.as_tensor(a))

    def _A_setup():
        B, S, D = (1, 2048, 576)
        ks = 4
        return {'q': _w((lambda *s: torch.randn(*s, dtype=torch.bfloat16) * 0.05)(B, S, D)), 'k': _w((lambda *s: torch.randn(*s, dtype=torch.bfloat16) * 0.8)(B, S, D)), 'v': _w((lambda *s: torch.randn(*s, dtype=torch.bfloat16) * 0.8)(B, S, D)), 'shift_k': _w((lambda *s: torch.randn(*s, dtype=torch.bfloat16) * 0.8)(D, ks) * 0.5), 'ssm_k': _w((lambda *s: torch.randn(*s, dtype=torch.bfloat16) * 0.8)(D, S) * (1.0 / S ** 0.5)), 'ssm_D': _w((lambda *s: torch.randn(*s, dtype=torch.bfloat16) * 0.8)(D))}
    _A_in = _A_setup()

    def _B_setup():
        B, S, D, F = (1, 2048, 576, 4608)
        return {'x': _w((lambda *s: torch.randn(*s, dtype=torch.bfloat16) * 0.05)(B, S, D)), 'w1': _w((lambda *s: torch.randn(*s, dtype=torch.bfloat16) * 0.8)(D, F) * (2.0 / D) ** 0.5), 'w3': _w((lambda *s: torch.randn(*s, dtype=torch.bfloat16) * 0.8)(D, F) * (2.0 / D) ** 0.5), 'w2': _w((lambda *s: torch.randn(*s, dtype=torch.bfloat16) * 0.8)(F, D) * (2.0 / F) ** 0.5)}
    _B_in = _B_setup()
    return {'A_q': _A_in['q'], 'A_k': _A_in['k'], 'A_v': _A_in['v'], 'A_shift_k': _A_in['shift_k'], 'A_ssm_k': _A_in['ssm_k'], 'A_ssm_D': _A_in['ssm_D'], 'B_x': _B_in['x'], 'B_w1': _B_in['w1'], 'B_w3': _B_in['w3'], 'B_w2': _B_in['w2'], 'c': _w((lambda *s: torch.randn(*s, dtype=torch.bfloat16) * 0.2)(1, 576) * 8.0), 'w_mod': _w((lambda *s: torch.randn(*s, dtype=torch.bfloat16) * 0.2)(576, 6 * 576) * 576 ** (-0.5) * 8.0)}

def reference(A_q, A_k, A_v, A_shift_k, A_ssm_k, A_ssm_D, B_x, B_w1, B_w3, B_w2, c, w_mod):

    def _A_ref(q, k, v, shift_k, ssm_k, ssm_D):
        B, S, D = q.shape
        ks = shift_k.shape[-1]
        k_pad = _pad(k, ((0, 0), (ks - 1, 0), (0, 0)))
        k_shift = torch.zeros_like(k)
        for t in range(ks):
            k_shift = k_shift + k_pad[:, t:t + S, :] * shift_k[:, ks - 1 - t][None, None, :]
        kv = k_shift * v
        L = 2 * S
        kv_pad = _pad(kv, ((0, 0), (0, S), (0, 0)))
        kf_pad = _pad(ssm_k, ((0, 0), (0, S)))
        kv_f = (lambda x, axes=(-2, -1): torch.fft.rfft2(x.float(), dim=axes))(kv_pad[:, None, :, :], axes=(1, 2))
        kf_f = (lambda x, axes=(-2, -1): torch.fft.rfft2(x.float(), dim=axes))(kf_pad[:, None, :], axes=(1, 2))
        kf_f = (lambda x, *d: x.permute(*d))(kf_f, 1, 2, 0)
        y_f = kv_f * kf_f[None, :, :, :]
        y = (lambda x, s, axes=(-2, -1): torch.fft.irfft2(x, s=s, dim=axes).to(torch.bfloat16))(y_f, (1, L), axes=(1, 2))[:, 0, :S, :]
        y = y + kv * ssm_D[None, None, :]
        return q * y

    def _B_ref(x, w1, w3, w2):
        gate = torch.einsum('bsd,df->bsf', x, w1)
        up = torch.einsum('bsd,df->bsf', x, w3)
        h = _silu(gate) * up
        out = torch.einsum('bsf,fd->bsd', h, w2)
        return out
    x = A_q
    mod = (_silu(c) @ w_mod).reshape(c.shape[0], 6, 1, -1)
    sa, ca, ga, sb, cb, gb = (mod[:, 0].clone(), mod[:, 1].clone(), mod[:, 2].clone(), mod[:, 3].clone(), mod[:, 4].clone(), mod[:, 5].clone())
    h = _layernorm(x, axis=-1) * (1 + ca) + sa
    x = x + ga * _A_ref(h, A_k, A_v, A_shift_k, A_ssm_k, A_ssm_D)
    h = _layernorm(x, axis=-1) * (1 + cb) + sb
    x = x + gb * _B_ref(h, B_w1, B_w3, B_w2)
    return x
```

```asm
; @launch kernel=front_kernel grid=(252,1,1) block=(256,1,1) lds=131072
; @launch kernel=ffn_kernel grid=(256,1,1) block=(256,1,1) lds=135680
.amdgcn_target "amdgcn-amd-amdhsa--gfx950"
.text
.globl front_kernel
.p2align 8
.type front_kernel,@function
front_kernel:
s_cmp_ge_u32 s2, 252
s_cbranch_scc1 front_kernel_done
s_cmp_ge_u32 s2, 144
s_cbranch_scc1 front_kernel_bg
s_load_dwordx2 s[4:5], s[0:1], 32
s_load_dwordx2 s[6:7], s[0:1], 112
s_load_dwordx2 s[8:9], s[0:1], 40
s_load_dwordx2 s[48:49], s[0:1], 8
s_load_dwordx2 s[50:51], s[0:1], 16
s_load_dwordx2 s[52:53], s[0:1], 24
s_load_dwordx2 s[54:55], s[0:1], 104
v_lshrrev_b32 v1, 6, v0
s_nop 0
v_readfirstlane_b32 s12, v1
s_nop 3
s_lshl_b32 s13, s2, 2
s_add_u32 s13, s13, s12
s_lshl_b32 s14, s13, 12
s_mul_i32 s15, s12, 21248
s_mul_i32 s42, s2, 7282
s_lshr_b32 s42, s42, 16
s_mul_i32 s43, s42, 9
s_sub_u32 s43, s2, s43
v_and_b32 v1, 63, v0
v_lshlrev_b32 v2, 4, v1
v_and_b32 v3, 7, v0
v_lshrrev_b32 v4, 3, v0
s_waitcnt lgkmcnt(0)
s_add_u32 s56, s48, 0
s_addc_u32 s57, s49, 0
s_and_b32 s57, s57, 0xffff
s_mov_b32 s58, 2359296
s_mov_b32 s59, 0x00020000
s_add_u32 s60, s50, 0
s_addc_u32 s61, s51, 0
s_and_b32 s61, s61, 0xffff
s_mov_b32 s62, 2359296
s_mov_b32 s63, 0x00020000
s_add_u32 s68, s52, 0
s_addc_u32 s69, s53, 0
s_and_b32 s69, s69, 0xffff
s_mov_b32 s70, 4608
s_mov_b32 s71, 0x00020000
s_mul_i32 s44, s42, 147456
s_lshl_b32 s45, s43, 7
s_add_u32 s44, s44, s45
v_mul_u32_u24 v5, 4608, v4
v_lshl_add_u32 v5, v3, 4, v5
v_add_u32 v8, s44, v5
v_subrev_u32 v5, 3456, v8
v_subrev_u32 v6, 2304, v8
v_subrev_u32 v7, 1152, v8
v_add_u32 v9, 1152, v8
v_add_u32 v10, 2304, v8
v_add_u32 v11, 3456, v8
buffer_load_dwordx4 v[96:99], v5, s[56:59], 0 offen nt
buffer_load_dwordx4 v[100:103], v6, s[56:59], 0 offen nt
buffer_load_dwordx4 v[104:107], v7, s[56:59], 0 offen nt
buffer_load_dwordx4 v[108:111], v8, s[56:59], 0 offen nt
buffer_load_dwordx4 v[112:115], v9, s[56:59], 0 offen nt
buffer_load_dwordx4 v[116:119], v10, s[56:59], 0 offen nt
buffer_load_dwordx4 v[120:123], v11, s[56:59], 0 offen nt
buffer_load_dwordx4 v[124:127], v8, s[60:63], 0 offen nt
buffer_load_dwordx4 v[128:131], v9, s[60:63], 0 offen nt
buffer_load_dwordx4 v[132:135], v10, s[60:63], 0 offen nt
buffer_load_dwordx4 v[136:139], v11, s[60:63], 0 offen nt
s_lshl_b32 s45, s43, 9
v_lshlrev_b32 v12, 6, v3
v_add_u32 v12, s45, v12
buffer_load_dwordx4 v[140:143], v12, s[68:71], 0 offen offset:0
buffer_load_dwordx4 v[144:147], v12, s[68:71], 0 offen offset:16
buffer_load_dwordx4 v[148:151], v12, s[68:71], 0 offen offset:32
buffer_load_dwordx4 v[152:155], v12, s[68:71], 0 offen offset:48
s_add_u32 s16, s4, s14
s_addc_u32 s17, s5, 0
s_and_b32 s17, s17, 0xffff
s_mov_b32 s18, 4096
s_mov_b32 s19, 0x00020000
buffer_load_dwordx4 v[16:19], v2, s[16:19], 0 offen offset:0 nt
buffer_load_dwordx4 v[32:35], v2, s[16:19], 0 offen offset:4 nt
buffer_load_dword v48, v2, s[16:19], 0 offen offset:20 nt
buffer_load_dwordx4 v[20:23], v2, s[16:19], 0 offen offset:1024 nt
buffer_load_dwordx4 v[36:39], v2, s[16:19], 0 offen offset:1028 nt
buffer_load_dword v49, v2, s[16:19], 0 offen offset:1044 nt
buffer_load_dwordx4 v[24:27], v2, s[16:19], 0 offen offset:2048 nt
buffer_load_dwordx4 v[40:43], v2, s[16:19], 0 offen offset:2052 nt
buffer_load_dword v50, v2, s[16:19], 0 offen offset:2068 nt
buffer_load_dwordx4 v[28:31], v2, s[16:19], 0 offen offset:3072 nt
buffer_load_dwordx4 v[44:47], v2, s[16:19], 0 offen offset:3076 nt
buffer_load_dword v51, v2, s[16:19], 0 offen offset:3092 nt
s_add_u32 s32, s14, 65536
s_add_u32 s20, s6, s32
s_addc_u32 s21, s7, 0
s_and_b32 s21, s21, 0xffff
s_mov_b32 s22, 4096
s_mov_b32 s23, 0x00020000
s_add_u32 s32, s14, 2424832
s_add_u32 s24, s6, s32
s_addc_u32 s25, s7, 0
s_and_b32 s25, s25, 0xffff
s_mov_b32 s26, 4096
s_mov_b32 s27, 0x00020000
s_add_u32 s64, s6, 65536
s_addc_u32 s65, s7, 0
s_and_b32 s65, s65, 0xffff
s_mov_b32 s66, 2359296
s_mov_b32 s67, 0x00020000
s_add_u32 s72, s54, 0
s_addc_u32 s73, s55, 0
s_and_b32 s73, s73, 0xffff
s_mov_b32 s74, 256
s_mov_b32 s75, 0x00020000
s_add_u32 s80, s6, 44311552
s_addc_u32 s81, s7, 0
s_and_b32 s81, s81, 0xffff
s_mov_b32 s82, 1152
s_mov_b32 s83, 0x00020000
s_lshl_b32 s33, s13, 1
s_and_b32 s33, s33, 0xfffffffc
s_load_dword s34, s[8:9], s33
v_mul_u32_u24 v52, 576, v4
v_lshl_add_u32 v52, v3, 4, v52
v_add_u32 v52, 84992, v52
v_lshrrev_b32 v56, 4, v1
v_and_b32 v57, 15, v1
v_lshrrev_b32 v58, 2, v57
v_lshlrev_b32 v53, 3, v56
v_sub_u32 v53, v53, v58
v_add_u32 v53, 3, v53
v_mul_u32_u24 v53, 144, v53
v_and_b32 v58, 3, v57
v_lshl_add_u32 v53, v58, 3, v53
s_lshl_b32 s45, s12, 5
s_add_u32 s45, s45, 84992
v_add_u32 v53, s45, v53
s_mul_i32 s45, s12, 4352
s_add_u32 s45, s45, 103424
v_mul_u32_u24 v54, 272, v57
v_lshl_add_u32 v54, v56, 4, v54
v_add_u32 v54, s45, v54
v_mul_u32_u24 v55, 272, v56
v_lshl_add_u32 v55, v57, 4, v55
v_add_u32 v55, s45, v55
s_lshl_b32 s46, s43, 6
s_lshl_b32 s47, s12, 4
s_add_u32 s46, s46, s47
s_lshl_b32 s46, s46, 12
s_lshl_b32 s47, s42, 8
s_add_u32 s46, s46, s47
v_mov_b32 v60, 0
v_mov_b32 v61, 0
v_mov_b32 v62, 0
v_mov_b32 v63, 0
v_lshlrev_b32 v3, 3, v1
v_add_u32 v3, s15, v3
ds_write_b64 v3, v[60:61] offset:16640
v_lshrrev_b32 v4, 1, v1
v_mul_u32_u24 v4, 4160, v4
v_and_b32 v5, 1, v1
v_lshl_add_u32 v4, v5, 4, v4
v_add_u32 v4, s15, v4
v_cmp_gt_u32 vcc, 8, v1
s_and_saveexec_b64 s[40:41], vcc
ds_write_b128 v4, v[60:63]
s_mov_b64 exec, s[40:41]
s_waitcnt vmcnt(12)
v_lshlrev_b32 v156, 16, v140
v_and_b32 v158, 0xffff0000, v140
v_lshlrev_b32 v160, 16, v141
v_and_b32 v162, 0xffff0000, v141
v_lshlrev_b32 v157, 16, v142
v_and_b32 v159, 0xffff0000, v142
v_lshlrev_b32 v161, 16, v143
v_and_b32 v163, 0xffff0000, v143
v_lshlrev_b32 v164, 16, v96
v_and_b32 v165, 0xffff0000, v96
v_lshlrev_b32 v166, 16, v100
v_and_b32 v167, 0xffff0000, v100
v_lshlrev_b32 v168, 16, v104
v_and_b32 v169, 0xffff0000, v104
v_lshlrev_b32 v170, 16, v108
v_and_b32 v171, 0xffff0000, v108
v_lshlrev_b32 v172, 16, v112
v_and_b32 v173, 0xffff0000, v112
v_lshlrev_b32 v174, 16, v116
v_and_b32 v175, 0xffff0000, v116
v_lshlrev_b32 v176, 16, v120
v_and_b32 v177, 0xffff0000, v120
v_lshlrev_b32 v180, 16, v124
v_and_b32 v181, 0xffff0000, v124
v_lshlrev_b32 v182, 16, v128
v_and_b32 v183, 0xffff0000, v128
v_lshlrev_b32 v184, 16, v132
v_and_b32 v185, 0xffff0000, v132
v_lshlrev_b32 v186, 16, v136
v_and_b32 v187, 0xffff0000, v136
v_pk_mul_f32 v[64:65], v[164:165], v[162:163]
v_pk_mul_f32 v[72:73], v[166:167], v[162:163]
v_pk_mul_f32 v[80:81], v[168:169], v[162:163]
v_pk_mul_f32 v[88:89], v[170:171], v[162:163]
v_pk_fma_f32 v[64:65], v[166:167], v[160:161], v[64:65]
v_pk_fma_f32 v[72:73], v[168:169], v[160:161], v[72:73]
v_pk_fma_f32 v[80:81], v[170:171], v[160:161], v[80:81]
v_pk_fma_f32 v[88:89], v[172:173], v[160:161], v[88:89]
v_pk_fma_f32 v[64:65], v[168:169], v[158:159], v[64:65]
v_pk_fma_f32 v[72:73], v[170:171], v[158:159], v[72:73]
v_pk_fma_f32 v[80:81], v[172:173], v[158:159], v[80:81]
v_pk_fma_f32 v[88:89], v[174:175], v[158:159], v[88:89]
v_pk_fma_f32 v[64:65], v[170:171], v[156:157], v[64:65]
v_pk_fma_f32 v[72:73], v[172:173], v[156:157], v[72:73]
v_pk_fma_f32 v[80:81], v[174:175], v[156:157], v[80:81]
v_pk_fma_f32 v[88:89], v[176:177], v[156:157], v[88:89]
v_pk_mul_f32 v[64:65], v[64:65], v[180:181]
v_pk_mul_f32 v[72:73], v[72:73], v[182:183]
v_pk_mul_f32 v[80:81], v[80:81], v[184:185]
v_pk_mul_f32 v[88:89], v[88:89], v[186:187]
v_lshlrev_b32 v156, 16, v144
v_and_b32 v158, 0xffff0000, v144
v_lshlrev_b32 v160, 16, v145
v_and_b32 v162, 0xffff0000, v145
v_lshlrev_b32 v157, 16, v146
v_and_b32 v159, 0xffff0000, v146
v_lshlrev_b32 v161, 16, v147
v_and_b32 v163, 0xffff0000, v147
v_lshlrev_b32 v164, 16, v97
v_and_b32 v165, 0xffff0000, v97
v_lshlrev_b32 v166, 16, v101
v_and_b32 v167, 0xffff0000, v101
v_lshlrev_b32 v168, 16, v105
v_and_b32 v169, 0xffff0000, v105
v_lshlrev_b32 v170, 16, v109
v_and_b32 v171, 0xffff0000, v109
v_lshlrev_b32 v172, 16, v113
v_and_b32 v173, 0xffff0000, v113
v_lshlrev_b32 v174, 16, v117
v_and_b32 v175, 0xffff0000, v117
v_lshlrev_b32 v176, 16, v121
v_and_b32 v177, 0xffff0000, v121
v_lshlrev_b32 v180, 16, v125
v_and_b32 v181, 0xffff0000, v125
v_lshlrev_b32 v182, 16, v129
v_and_b32 v183, 0xffff0000, v129
v_lshlrev_b32 v184, 16, v133
v_and_b32 v185, 0xffff0000, v133
v_lshlrev_b32 v186, 16, v137
v_and_b32 v187, 0xffff0000, v137
v_pk_mul_f32 v[66:67], v[164:165], v[162:163]
v_pk_mul_f32 v[74:75], v[166:167], v[162:163]
v_pk_mul_f32 v[82:83], v[168:169], v[162:163]
v_pk_mul_f32 v[90:91], v[170:171], v[162:163]
v_pk_fma_f32 v[66:67], v[166:167], v[160:161], v[66:67]
v_pk_fma_f32 v[74:75], v[168:169], v[160:161], v[74:75]
v_pk_fma_f32 v[82:83], v[170:171], v[160:161], v[82:83]
v_pk_fma_f32 v[90:91], v[172:173], v[160:161], v[90:91]
v_pk_fma_f32 v[66:67], v[168:169], v[158:159], v[66:67]
v_pk_fma_f32 v[74:75], v[170:171], v[158:159], v[74:75]
v_pk_fma_f32 v[82:83], v[172:173], v[158:159], v[82:83]
v_pk_fma_f32 v[90:91], v[174:175], v[158:159], v[90:91]
v_pk_fma_f32 v[66:67], v[170:171], v[156:157], v[66:67]
v_pk_fma_f32 v[74:75], v[172:173], v[156:157], v[74:75]
v_pk_fma_f32 v[82:83], v[174:175], v[156:157], v[82:83]
v_pk_fma_f32 v[90:91], v[176:177], v[156:157], v[90:91]
v_pk_mul_f32 v[66:67], v[66:67], v[180:181]
v_pk_mul_f32 v[74:75], v[74:75], v[182:183]
v_pk_mul_f32 v[82:83], v[82:83], v[184:185]
v_pk_mul_f32 v[90:91], v[90:91], v[186:187]
v_lshlrev_b32 v156, 16, v148
v_and_b32 v158, 0xffff0000, v148
v_lshlrev_b32 v160, 16, v149
v_and_b32 v162, 0xffff0000, v149
v_lshlrev_b32 v157, 16, v150
v_and_b32 v159, 0xffff0000, v150
v_lshlrev_b32 v161, 16, v151
v_and_b32 v163, 0xffff0000, v151
v_lshlrev_b32 v164, 16, v98
v_and_b32 v165, 0xffff0000, v98
v_lshlrev_b32 v166, 16, v102
v_and_b32 v167, 0xffff0000, v102
v_lshlrev_b32 v168, 16, v106
v_and_b32 v169, 0xffff0000, v106
v_lshlrev_b32 v170, 16, v110
v_and_b32 v171, 0xffff0000, v110
v_lshlrev_b32 v172, 16, v114
v_and_b32 v173, 0xffff0000, v114
v_lshlrev_b32 v174, 16, v118
v_and_b32 v175, 0xffff0000, v118
v_lshlrev_b32 v176, 16, v122
v_and_b32 v177, 0xffff0000, v122
v_lshlrev_b32 v180, 16, v126
v_and_b32 v181, 0xffff0000, v126
v_lshlrev_b32 v182, 16, v130
v_and_b32 v183, 0xffff0000, v130
v_lshlrev_b32 v184, 16, v134
v_and_b32 v185, 0xffff0000, v134
v_lshlrev_b32 v186, 16, v138
v_and_b32 v187, 0xffff0000, v138
v_pk_mul_f32 v[68:69], v[164:165], v[162:163]
v_pk_mul_f32 v[76:77], v[166:167], v[162:163]
v_pk_mul_f32 v[84:85], v[168:169], v[162:163]
v_pk_mul_f32 v[92:93], v[170:171], v[162:163]
v_pk_fma_f32 v[68:69], v[166:167], v[160:161], v[68:69]
v_pk_fma_f32 v[76:77], v[168:169], v[160:161], v[76:77]
v_pk_fma_f32 v[84:85], v[170:171], v[160:161], v[84:85]
v_pk_fma_f32 v[92:93], v[172:173], v[160:161], v[92:93]
v_pk_fma_f32 v[68:69], v[168:169], v[158:159], v[68:69]
v_pk_fma_f32 v[76:77], v[170:171], v[158:159], v[76:77]
v_pk_fma_f32 v[84:85], v[172:173], v[158:159], v[84:85]
v_pk_fma_f32 v[92:93], v[174:175], v[158:159], v[92:93]
v_pk_fma_f32 v[68:69], v[170:171], v[156:157], v[68:69]
v_pk_fma_f32 v[76:77], v[172:173], v[156:157], v[76:77]
v_pk_fma_f32 v[84:85], v[174:175], v[156:157], v[84:85]
v_pk_fma_f32 v[92:93], v[176:177], v[156:157], v[92:93]
v_pk_mul_f32 v[68:69], v[68:69], v[180:181]
v_pk_mul_f32 v[76:77], v[76:77], v[182:183]
v_pk_mul_f32 v[84:85], v[84:85], v[184:185]
v_pk_mul_f32 v[92:93], v[92:93], v[186:187]
v_lshlrev_b32 v156, 16, v152
v_and_b32 v158, 0xffff0000, v152
v_lshlrev_b32 v160, 16, v153
v_and_b32 v162, 0xffff0000, v153
v_lshlrev_b32 v157, 16, v154
v_and_b32 v159, 0xffff0000, v154
v_lshlrev_b32 v161, 16, v155
v_and_b32 v163, 0xffff0000, v155
v_lshlrev_b32 v164, 16, v99
v_and_b32 v165, 0xffff0000, v99
v_lshlrev_b32 v166, 16, v103
v_and_b32 v167, 0xffff0000, v103
v_lshlrev_b32 v168, 16, v107
v_and_b32 v169, 0xffff0000, v107
v_lshlrev_b32 v170, 16, v111
v_and_b32 v171, 0xffff0000, v111
v_lshlrev_b32 v172, 16, v115
v_and_b32 v173, 0xffff0000, v115
v_lshlrev_b32 v174, 16, v119
v_and_b32 v175, 0xffff0000, v119
v_lshlrev_b32 v176, 16, v123
v_and_b32 v177, 0xffff0000, v123
v_lshlrev_b32 v180, 16, v127
v_and_b32 v181, 0xffff0000, v127
v_lshlrev_b32 v182, 16, v131
v_and_b32 v183, 0xffff0000, v131
v_lshlrev_b32 v184, 16, v135
v_and_b32 v185, 0xffff0000, v135
v_lshlrev_b32 v186, 16, v139
v_and_b32 v187, 0xffff0000, v139
v_pk_mul_f32 v[70:71], v[164:165], v[162:163]
v_pk_mul_f32 v[78:79], v[166:167], v[162:163]
v_pk_mul_f32 v[86:87], v[168:169], v[162:163]
v_pk_mul_f32 v[94:95], v[170:171], v[162:163]
v_pk_fma_f32 v[70:71], v[166:167], v[160:161], v[70:71]
v_pk_fma_f32 v[78:79], v[168:169], v[160:161], v[78:79]
v_pk_fma_f32 v[86:87], v[170:171], v[160:161], v[86:87]
v_pk_fma_f32 v[94:95], v[172:173], v[160:161], v[94:95]
v_pk_fma_f32 v[70:71], v[168:169], v[158:159], v[70:71]
v_pk_fma_f32 v[78:79], v[170:171], v[158:159], v[78:79]
v_pk_fma_f32 v[86:87], v[172:173], v[158:159], v[86:87]
v_pk_fma_f32 v[94:95], v[174:175], v[158:159], v[94:95]
v_pk_fma_f32 v[70:71], v[170:171], v[156:157], v[70:71]
v_pk_fma_f32 v[78:79], v[172:173], v[156:157], v[78:79]
v_pk_fma_f32 v[86:87], v[174:175], v[156:157], v[86:87]
v_pk_fma_f32 v[94:95], v[176:177], v[156:157], v[94:95]
v_pk_mul_f32 v[70:71], v[70:71], v[180:181]
v_pk_mul_f32 v[78:79], v[78:79], v[182:183]
v_pk_mul_f32 v[86:87], v[86:87], v[184:185]
v_pk_mul_f32 v[94:95], v[94:95], v[186:187]
v_cvt_pk_bf16_f32 v172, v64, v65
v_cvt_pk_bf16_f32 v173, v66, v67
v_cvt_pk_bf16_f32 v174, v68, v69
v_cvt_pk_bf16_f32 v175, v70, v71
ds_write_b128 v52, v[172:175] offset:0
v_cvt_pk_bf16_f32 v176, v72, v73
v_cvt_pk_bf16_f32 v177, v74, v75
v_cvt_pk_bf16_f32 v178, v76, v77
v_cvt_pk_bf16_f32 v179, v78, v79
ds_write_b128 v52, v[176:179] offset:144
v_cvt_pk_bf16_f32 v180, v80, v81
v_cvt_pk_bf16_f32 v181, v82, v83
v_cvt_pk_bf16_f32 v182, v84, v85
v_cvt_pk_bf16_f32 v183, v86, v87
ds_write_b128 v52, v[180:183] offset:288
v_cvt_pk_bf16_f32 v184, v88, v89
v_cvt_pk_bf16_f32 v185, v90, v91
v_cvt_pk_bf16_f32 v186, v92, v93
v_cvt_pk_bf16_f32 v187, v94, v95
ds_write_b128 v52, v[184:187] offset:432
s_waitcnt lgkmcnt(0)
s_barrier
ds_read_b64_tr_b16 v[64:65], v53 offset:576
ds_read_b64_tr_b16 v[66:67], v53 offset:0
ds_read_b64_tr_b16 v[68:69], v53 offset:5184
ds_read_b64_tr_b16 v[70:71], v53 offset:4608
ds_read_b64_tr_b16 v[72:73], v53 offset:9792
ds_read_b64_tr_b16 v[74:75], v53 offset:9216
ds_read_b64_tr_b16 v[76:77], v53 offset:14400
ds_read_b64_tr_b16 v[78:79], v53 offset:13824
s_waitcnt lgkmcnt(6)
ds_write_b128 v54, v[64:67] offset:0
s_waitcnt lgkmcnt(5)
ds_write_b128 v54, v[68:71] offset:64
s_waitcnt lgkmcnt(4)
ds_write_b128 v54, v[72:75] offset:128
s_waitcnt lgkmcnt(3)
ds_write_b128 v54, v[76:79] offset:192
s_waitcnt lgkmcnt(0)
v_lshrrev_b32 v96, 4, v1
v_lshlrev_b32 v96, 12, v96
v_and_b32 v97, 15, v1
v_lshl_add_u32 v96, v97, 4, v96
ds_read_b128 v[80:83], v55 offset:0
ds_read_b128 v[84:87], v55 offset:1088
ds_read_b128 v[88:91], v55 offset:2176
ds_read_b128 v[92:95], v55 offset:3264
s_waitcnt lgkmcnt(3)
s_add_u32 s47, s46, 0
buffer_store_dwordx4 v[80:83], v96, s[64:67], s47 offen sc1
s_waitcnt lgkmcnt(2)
s_add_u32 s47, s46, 16384
buffer_store_dwordx4 v[84:87], v96, s[64:67], s47 offen sc1
s_waitcnt lgkmcnt(1)
s_add_u32 s47, s46, 32768
buffer_store_dwordx4 v[88:91], v96, s[64:67], s47 offen sc1
s_waitcnt lgkmcnt(0)
s_add_u32 s47, s46, 49152
buffer_store_dwordx4 v[92:95], v96, s[64:67], s47 offen sc1
v_mov_b32 v56, 0
buffer_load_dword v59, v56, s[72:75], 0 offen sc1
v_and_b32 v6, 15, v1
v_lshrrev_b32 v7, 4, v1
v_lshrrev_b32 v8, 1, v7
v_and_b32 v9, 1, v7
v_add_u32 v10, 1, v6
v_and_b32 v10, 3, v10
v_mul_u32_u24 v10, 4160, v10
v_add_u32 v11, 9, v6
v_and_b32 v11, 0xfffffffc, v11
v_lshl_add_u32 v11, v8, 4, v11
v_lshlrev_b32 v12, 3, v9
v_sub_u32 v11, v11, v12
v_lshl_add_u32 v10, v11, 1, v10
v_add_u32 v10, s15, v10
v_lshlrev_b32 v11, 1, v6
v_add_u32 v11, v11, v9
v_lshlrev_b32 v12, 1, v8
v_sub_u32 v11, v11, v12
v_add_u32 v11, 4, v11
v_lshlrev_b32 v11, 4, v11
s_add_u32 s35, s15, 16640
v_add_u32 v11, s35, v11
v_lshlrev_b32 v13, 5, v6
v_lshl_add_u32 v14, v7, 3, v13
v_lshl_add_u32 v13, v8, 4, v13
v_xor_b32 v12, 1, v9
v_lshl_add_u32 v13, v12, 3, v13
s_add_u32 s35, s15, 17152
v_add_u32 v13, s35, v13
v_add_u32 v15, s15, v2
s_waitcnt vmcnt(14)
ds_write_b128 v15, v[16:19] offset:32
v_alignbit_b32 v60, v17, v16, 16
v_alignbit_b32 v61, v18, v17, 16
v_alignbit_b32 v62, v19, v18, 16
v_alignbit_b32 v63, v35, v19, 16
ds_write_b128 v15, v[32:35] offset:8352
v_alignbit_b32 v64, v33, v32, 16
v_alignbit_b32 v65, v34, v33, 16
v_alignbit_b32 v66, v35, v34, 16
v_alignbit_b32 v67, v48, v35, 16
ds_write_b128 v15, v[60:63] offset:4192
ds_write_b128 v15, v[64:67] offset:12512
s_waitcnt vmcnt(11)
ds_write_b128 v15, v[20:23] offset:1056
v_alignbit_b32 v68, v21, v20, 16
v_alignbit_b32 v69, v22, v21, 16
v_alignbit_b32 v70, v23, v22, 16
v_alignbit_b32 v71, v39, v23, 16
ds_write_b128 v15, v[36:39] offset:9376
v_alignbit_b32 v72, v37, v36, 16
v_alignbit_b32 v73, v38, v37, 16
v_alignbit_b32 v74, v39, v38, 16
v_alignbit_b32 v75, v49, v39, 16
ds_write_b128 v15, v[68:71] offset:5216
ds_write_b128 v15, v[72:75] offset:13536
s_waitcnt vmcnt(8)
ds_write_b128 v15, v[24:27] offset:2080
v_alignbit_b32 v60, v25, v24, 16
v_alignbit_b32 v61, v26, v25, 16
v_alignbit_b32 v62, v27, v26, 16
v_alignbit_b32 v63, v43, v27, 16
ds_write_b128 v15, v[40:43] offset:10400
v_alignbit_b32 v64, v41, v40, 16
v_alignbit_b32 v65, v42, v41, 16
v_alignbit_b32 v66, v43, v42, 16
v_alignbit_b32 v67, v50, v43, 16
ds_write_b128 v15, v[60:63] offset:6240
ds_write_b128 v15, v[64:67] offset:14560
s_waitcnt vmcnt(5)
ds_write_b128 v15, v[28:31] offset:3104
v_alignbit_b32 v68, v29, v28, 16
v_alignbit_b32 v69, v30, v29, 16
v_alignbit_b32 v70, v31, v30, 16
v_alignbit_b32 v71, v47, v31, 16
ds_write_b128 v15, v[44:47] offset:11424
v_alignbit_b32 v72, v45, v44, 16
v_alignbit_b32 v73, v46, v45, 16
v_alignbit_b32 v74, v47, v46, 16
v_alignbit_b32 v75, v51, v47, 16
ds_write_b128 v15, v[68:71] offset:7264
ds_write_b128 v15, v[72:75] offset:15584
v_lshlrev_b32 v76, 16, v16
v_alignbit_b32 v77, v17, v16, 16
v_mov_b32 v78, s15
s_mov_b64 s[40:41], exec
s_mov_b64 exec, 1
ds_write_b32 v78, v76 offset:4188
ds_write_b32 v78, v16 offset:8348
ds_write_b64 v78, v[76:77] offset:12504
s_mov_b64 exec, s[40:41]
s_waitcnt vmcnt(0)
s_barrier
s_cmp_lg_u32 s12, 0
s_cbranch_scc1 front_kernel_got
s_mov_b32 s45, 20000
v_mov_b32 v56, 0
v_readfirstlane_b32 s76, v59
s_nop 3
s_cmp_eq_u32 s76, 1
s_cbranch_scc1 front_kernel_inited
front_kernel_init:
buffer_load_dword v57, v56, s[72:75], 0 offen sc1
s_waitcnt vmcnt(0)
v_readfirstlane_b32 s76, v57
s_nop 3
s_cmp_eq_u32 s76, 1
s_cbranch_scc1 front_kernel_inited
s_sub_u32 s45, s45, 1
s_cmp_eq_u32 s45, 0
s_cbranch_scc1 front_kernel_inited
s_sleep 4
s_branch front_kernel_init
front_kernel_inited:
s_lshl_b32 s44, s43, 7
s_lshl_b32 s45, s42, 2
s_add_u32 s44, s44, s45
v_mov_b32 v57, 1
s_mov_b64 s[40:41], exec
s_mov_b64 exec, 1
buffer_store_dword v57, v56, s[80:83], s44 offen sc1
s_mov_b64 exec, s[40:41]
s_lshr_b32 s44, s2, 4
s_lshl_b32 s44, s44, 7
s_mov_b32 s45, 20000
v_lshlrev_b32 v56, 2, v1
v_mov_b32 v57, 0x7f000000
v_cmp_gt_u32 vcc, 16, v1
s_mov_b32 s78, 0xffff
s_mov_b32 s79, 0
v_cndmask_b32 v56, v57, v56, vcc
front_kernel_poll:
buffer_load_dword v57, v56, s[80:83], s44 offen sc1
s_waitcnt vmcnt(0)
v_cmp_eq_u32 vcc, 1, v57
s_nop 3
s_cmp_eq_u64 vcc, s[78:79]
s_cbranch_scc1 front_kernel_got
s_sub_u32 s45, s45, 1
s_cmp_eq_u32 s45, 0
s_cbranch_scc1 front_kernel_got
s_sleep 4
s_branch front_kernel_poll
front_kernel_got:
s_barrier
s_add_u32 m0, s15, 17152
s_nop 0
buffer_load_dwordx4 v2, s[20:23], 0 offen offset:0 sc1 lds
buffer_load_dwordx4 v2, s[20:23], 0 offen offset:1024 sc1 lds
buffer_load_dwordx4 v2, s[20:23], 0 offen offset:2048 sc1 lds
buffer_load_dwordx4 v2, s[20:23], 0 offen offset:3072 sc1 lds
v_mov_b32 v16, 0
v_mov_b32 v17, 0
v_mov_b32 v18, 0
v_mov_b32 v19, 0
v_mov_b32 v20, 0
v_mov_b32 v21, 0
v_mov_b32 v22, 0
v_mov_b32 v23, 0
v_mov_b32 v24, 0
v_mov_b32 v25, 0
v_mov_b32 v26, 0
v_mov_b32 v27, 0
v_mov_b32 v28, 0
v_mov_b32 v29, 0
v_mov_b32 v30, 0
v_mov_b32 v31, 0
v_mov_b32 v32, 0
v_mov_b32 v33, 0
v_mov_b32 v34, 0
v_mov_b32 v35, 0
v_mov_b32 v36, 0
v_mov_b32 v37, 0
v_mov_b32 v38, 0
v_mov_b32 v39, 0
v_mov_b32 v40, 0
v_mov_b32 v41, 0
v_mov_b32 v42, 0
v_mov_b32 v43, 0
v_mov_b32 v44, 0
v_mov_b32 v45, 0
v_mov_b32 v46, 0
v_mov_b32 v47, 0
s_waitcnt vmcnt(0) lgkmcnt(0)
s_lshl_b32 s36, s34, 16
s_and_b32 s37, s34, 0xffff0000
s_bitcmp1_b32 s13, 0
s_cselect_b32 s36, s37, s36
ds_read_b128 v[96:99], v11 offset:448
ds_read_b128 v[100:103], v11 offset:960
ds_read_b128 v[104:107], v11 offset:1472
ds_read_b128 v[108:111], v11 offset:1984
ds_read_b128 v[112:115], v11 offset:2496
ds_read_b128 v[116:119], v11 offset:3008
ds_read_b128 v[120:123], v11 offset:3520
ds_read_b128 v[124:127], v11 offset:4032
ds_read_b64 v[64:65], v10 offset:0
ds_read_b64 v[66:67], v10 offset:8
ds_read_b64 v[68:69], v10 offset:512
ds_read_b64 v[70:71], v10 offset:520
ds_read_b64 v[72:73], v10 offset:1024
ds_read_b64 v[74:75], v10 offset:1032
ds_read_b64 v[76:77], v10 offset:1536
ds_read_b64 v[78:79], v10 offset:1544
ds_read_b64 v[80:81], v10 offset:2048
ds_read_b64 v[82:83], v10 offset:2056
ds_read_b64 v[84:85], v10 offset:2560
ds_read_b64 v[86:87], v10 offset:2568
ds_read_b64 v[88:89], v10 offset:3072
ds_read_b64 v[90:91], v10 offset:3080
ds_read_b64 v[92:93], v10 offset:3584
ds_read_b64 v[94:95], v10 offset:3592
s_mov_b32 s38, 4
front_kernel_loop:
s_waitcnt lgkmcnt(0)
v_mfma_f32_16x16x32_bf16 v[16:19], v[64:67], v[96:99], v[16:19]
ds_read_b128 v[160:163], v11 offset:384
v_mfma_f32_16x16x32_bf16 v[20:23], v[64:67], v[100:103], v[20:23]
ds_read_b128 v[164:167], v11 offset:896
v_mfma_f32_16x16x32_bf16 v[24:27], v[64:67], v[104:107], v[24:27]
ds_read_b128 v[168:171], v11 offset:1408
v_mfma_f32_16x16x32_bf16 v[28:31], v[64:67], v[108:111], v[28:31]
ds_read_b128 v[172:175], v11 offset:1920
v_mfma_f32_16x16x32_bf16 v[32:35], v[64:67], v[112:115], v[32:35]
ds_read_b128 v[176:179], v11 offset:2432
v_mfma_f32_16x16x32_bf16 v[36:39], v[64:67], v[116:119], v[36:39]
ds_read_b128 v[180:183], v11 offset:2944
v_mfma_f32_16x16x32_bf16 v[40:43], v[64:67], v[120:123], v[40:43]
ds_read_b128 v[184:187], v11 offset:3456
v_mfma_f32_16x16x32_bf16 v[44:47], v[64:67], v[124:127], v[44:47]
ds_read_b128 v[188:191], v11 offset:3968
v_mfma_f32_16x16x32_bf16 v[20:23], v[68:71], v[96:99], v[20:23]
ds_read_b64 v[128:129], v10 offset:64
v_mfma_f32_16x16x32_bf16 v[24:27], v[68:71], v[100:103], v[24:27]
ds_read_b64 v[130:131], v10 offset:72
v_mfma_f32_16x16x32_bf16 v[28:31], v[68:71], v[104:107], v[28:31]
ds_read_b64 v[132:133], v10 offset:576
v_mfma_f32_16x16x32_bf16 v[32:35], v[68:71], v[108:111], v[32:35]
ds_read_b64 v[134:135], v10 offset:584
v_mfma_f32_16x16x32_bf16 v[36:39], v[68:71], v[112:115], v[36:39]
ds_read_b64 v[136:137], v10 offset:1088
v_mfma_f32_16x16x32_bf16 v[40:43], v[68:71], v[116:119], v[40:43]
ds_read_b64 v[138:139], v10 offset:1096
v_mfma_f32_16x16x32_bf16 v[44:47], v[68:71], v[120:123], v[44:47]
ds_read_b64 v[140:141], v10 offset:1600
v_mfma_f32_16x16x32_bf16 v[24:27], v[72:75], v[96:99], v[24:27]
ds_read_b64 v[142:143], v10 offset:1608
v_mfma_f32_16x16x32_bf16 v[28:31], v[72:75], v[100:103], v[28:31]
ds_read_b64 v[144:145], v10 offset:2112
v_mfma_f32_16x16x32_bf16 v[32:35], v[72:75], v[104:107], v[32:35]
ds_read_b64 v[146:147], v10 offset:2120
v_mfma_f32_16x16x32_bf16 v[36:39], v[72:75], v[108:111], v[36:39]
ds_read_b64 v[148:149], v10 offset:2624
v_mfma_f32_16x16x32_bf16 v[40:43], v[72:75], v[112:115], v[40:43]
ds_read_b64 v[150:151], v10 offset:2632
v_mfma_f32_16x16x32_bf16 v[44:47], v[72:75], v[116:119], v[44:47]
ds_read_b64 v[152:153], v10 offset:3136
v_mfma_f32_16x16x32_bf16 v[28:31], v[76:79], v[96:99], v[28:31]
ds_read_b64 v[154:155], v10 offset:3144
v_mfma_f32_16x16x32_bf16 v[32:35], v[76:79], v[100:103], v[32:35]
ds_read_b64 v[156:157], v10 offset:3648
v_mfma_f32_16x16x32_bf16 v[36:39], v[76:79], v[104:107], v[36:39]
ds_read_b64 v[158:159], v10 offset:3656
v_mfma_f32_16x16x32_bf16 v[40:43], v[76:79], v[108:111], v[40:43]
v_mfma_f32_16x16x32_bf16 v[44:47], v[76:79], v[112:115], v[44:47]
v_mfma_f32_16x16x32_bf16 v[32:35], v[80:83], v[96:99], v[32:35]
v_mfma_f32_16x16x32_bf16 v[36:39], v[80:83], v[100:103], v[36:39]
v_mfma_f32_16x16x32_bf16 v[40:43], v[80:83], v[104:107], v[40:43]
v_mfma_f32_16x16x32_bf16 v[44:47], v[80:83], v[108:111], v[44:47]
v_mfma_f32_16x16x32_bf16 v[36:39], v[84:87], v[96:99], v[36:39]
v_mfma_f32_16x16x32_bf16 v[40:43], v[84:87], v[100:103], v[40:43]
v_mfma_f32_16x16x32_bf16 v[44:47], v[84:87], v[104:107], v[44:47]
v_mfma_f32_16x16x32_bf16 v[40:43], v[88:91], v[96:99], v[40:43]
v_mfma_f32_16x16x32_bf16 v[44:47], v[88:91], v[100:103], v[44:47]
v_mfma_f32_16x16x32_bf16 v[44:47], v[92:95], v[96:99], v[44:47]
s_waitcnt lgkmcnt(0)
v_mfma_f32_16x16x32_bf16 v[16:19], v[128:131], v[160:163], v[16:19]
ds_read_b128 v[96:99], v11 offset:320
v_mfma_f32_16x16x32_bf16 v[20:23], v[128:131], v[164:167], v[20:23]
ds_read_b128 v[100:103], v11 offset:832
v_mfma_f32_16x16x32_bf16 v[24:27], v[128:131], v[168:171], v[24:27]
ds_read_b128 v[104:107], v11 offset:1344
v_mfma_f32_16x16x32_bf16 v[28:31], v[128:131], v[172:175], v[28:31]
ds_read_b128 v[108:111], v11 offset:1856
v_mfma_f32_16x16x32_bf16 v[32:35], v[128:131], v[176:179], v[32:35]
ds_read_b128 v[112:115], v11 offset:2368
v_mfma_f32_16x16x32_bf16 v[36:39], v[128:131], v[180:183], v[36:39]
ds_read_b128 v[116:119], v11 offset:2880
v_mfma_f32_16x16x32_bf16 v[40:43], v[128:131], v[184:187], v[40:43]
ds_read_b128 v[120:123], v11 offset:3392
v_mfma_f32_16x16x32_bf16 v[44:47], v[128:131], v[188:191], v[44:47]
ds_read_b128 v[124:127], v11 offset:3904
v_mfma_f32_16x16x32_bf16 v[20:23], v[132:135], v[160:163], v[20:23]
ds_read_b64 v[64:65], v10 offset:128
v_mfma_f32_16x16x32_bf16 v[24:27], v[132:135], v[164:167], v[24:27]
ds_read_b64 v[66:67], v10 offset:136
v_mfma_f32_16x16x32_bf16 v[28:31], v[132:135], v[168:171], v[28:31]
ds_read_b64 v[68:69], v10 offset:640
v_mfma_f32_16x16x32_bf16 v[32:35], v[132:135], v[172:175], v[32:35]
ds_read_b64 v[70:71], v10 offset:648
v_mfma_f32_16x16x32_bf16 v[36:39], v[132:135], v[176:179], v[36:39]
ds_read_b64 v[72:73], v10 offset:1152
v_mfma_f32_16x16x32_bf16 v[40:43], v[132:135], v[180:183], v[40:43]
ds_read_b64 v[74:75], v10 offset:1160
v_mfma_f32_16x16x32_bf16 v[44:47], v[132:135], v[184:187], v[44:47]
ds_read_b64 v[76:77], v10 offset:1664
v_mfma_f32_16x16x32_bf16 v[24:27], v[136:139], v[160:163], v[24:27]
ds_read_b64 v[78:79], v10 offset:1672
v_mfma_f32_16x16x32_bf16 v[28:31], v[136:139], v[164:167], v[28:31]
ds_read_b64 v[80:81], v10 offset:2176
v_mfma_f32_16x16x32_bf16 v[32:35], v[136:139], v[168:171], v[32:35]
ds_read_b64 v[82:83], v10 offset:2184
v_mfma_f32_16x16x32_bf16 v[36:39], v[136:139], v[172:175], v[36:39]
ds_read_b64 v[84:85], v10 offset:2688
v_mfma_f32_16x16x32_bf16 v[40:43], v[136:139], v[176:179], v[40:43]
ds_read_b64 v[86:87], v10 offset:2696
v_mfma_f32_16x16x32_bf16 v[44:47], v[136:139], v[180:183], v[44:47]
ds_read_b64 v[88:89], v10 offset:3200
v_mfma_f32_16x16x32_bf16 v[28:31], v[140:143], v[160:163], v[28:31]
ds_read_b64 v[90:91], v10 offset:3208
v_mfma_f32_16x16x32_bf16 v[32:35], v[140:143], v[164:167], v[32:35]
ds_read_b64 v[92:93], v10 offset:3712
v_mfma_f32_16x16x32_bf16 v[36:39], v[140:143], v[168:171], v[36:39]
ds_read_b64 v[94:95], v10 offset:3720
v_mfma_f32_16x16x32_bf16 v[40:43], v[140:143], v[172:175], v[40:43]
v_mfma_f32_16x16x32_bf16 v[44:47], v[140:143], v[176:179], v[44:47]
v_mfma_f32_16x16x32_bf16 v[32:35], v[144:147], v[160:163], v[32:35]
v_mfma_f32_16x16x32_bf16 v[36:39], v[144:147], v[164:167], v[36:39]
v_mfma_f32_16x16x32_bf16 v[40:43], v[144:147], v[168:171], v[40:43]
v_mfma_f32_16x16x32_bf16 v[44:47], v[144:147], v[172:175], v[44:47]
v_mfma_f32_16x16x32_bf16 v[36:39], v[148:151], v[160:163], v[36:39]
v_mfma_f32_16x16x32_bf16 v[40:43], v[148:151], v[164:167], v[40:43]
v_mfma_f32_16x16x32_bf16 v[44:47], v[148:151], v[168:171], v[44:47]
v_mfma_f32_16x16x32_bf16 v[40:43], v[152:155], v[160:163], v[40:43]
v_mfma_f32_16x16x32_bf16 v[44:47], v[152:155], v[164:167], v[44:47]
v_mfma_f32_16x16x32_bf16 v[44:47], v[156:159], v[160:163], v[44:47]
v_add_u32 v10, 128, v10
v_subrev_u32 v11, 128, v11
s_sub_u32 s38, s38, 1
s_cmp_lg_u32 s38, 0
s_cbranch_scc1 front_kernel_loop
s_waitcnt lgkmcnt(0)
ds_read_b64 v[64:65], v13 offset:0
ds_read_b64 v[66:67], v13 offset:512
ds_read_b64 v[68:69], v13 offset:1024
ds_read_b64 v[70:71], v13 offset:1536
ds_read_b64 v[72:73], v13 offset:2048
ds_read_b64 v[74:75], v13 offset:2560
ds_read_b64 v[76:77], v13 offset:3072
ds_read_b64 v[78:79], v13 offset:3584
s_nop 4
s_waitcnt lgkmcnt(7)
v_and_b32 v96, 0xffff0000, v65
v_lshlrev_b32 v97, 16, v65
v_and_b32 v98, 0xffff0000, v64
v_lshlrev_b32 v99, 16, v64
v_fma_f32 v96, v96, s36, v16
v_fma_f32 v97, v97, s36, v17
v_fma_f32 v98, v98, s36, v18
v_fma_f32 v99, v99, s36, v19
v_cvt_pk_bf16_f32 v104, v96, v97
v_cvt_pk_bf16_f32 v105, v98, v99
buffer_store_dwordx2 v[104:105], v14, s[24:27], 0 offen offset:0 sc1
s_waitcnt lgkmcnt(6)
v_and_b32 v100, 0xffff0000, v67
v_lshlrev_b32 v101, 16, v67
v_and_b32 v102, 0xffff0000, v66
v_lshlrev_b32 v103, 16, v66
v_fma_f32 v100, v100, s36, v20
v_fma_f32 v101, v101, s36, v21
v_fma_f32 v102, v102, s36, v22
v_fma_f32 v103, v103, s36, v23
v_cvt_pk_bf16_f32 v106, v100, v101
v_cvt_pk_bf16_f32 v107, v102, v103
buffer_store_dwordx2 v[106:107], v14, s[24:27], 0 offen offset:512 sc1
s_waitcnt lgkmcnt(5)
v_and_b32 v96, 0xffff0000, v69
v_lshlrev_b32 v97, 16, v69
v_and_b32 v98, 0xffff0000, v68
v_lshlrev_b32 v99, 16, v68
v_fma_f32 v96, v96, s36, v24
v_fma_f32 v97, v97, s36, v25
v_fma_f32 v98, v98, s36, v26
v_fma_f32 v99, v99, s36, v27
v_cvt_pk_bf16_f32 v108, v96, v97
v_cvt_pk_bf16_f32 v109, v98, v99
buffer_store_dwordx2 v[108:109], v14, s[24:27], 0 offen offset:1024 sc1
s_waitcnt lgkmcnt(4)
v_and_b32 v100, 0xffff0000, v71
v_lshlrev_b32 v101, 16, v71
v_and_b32 v102, 0xffff0000, v70
v_lshlrev_b32 v103, 16, v70
v_fma_f32 v100, v100, s36, v28
v_fma_f32 v101, v101, s36, v29
v_fma_f32 v102, v102, s36, v30
v_fma_f32 v103, v103, s36, v31
v_cvt_pk_bf16_f32 v110, v100, v101
v_cvt_pk_bf16_f32 v111, v102, v103
buffer_store_dwordx2 v[110:111], v14, s[24:27], 0 offen offset:1536 sc1
s_waitcnt lgkmcnt(3)
v_and_b32 v96, 0xffff0000, v73
v_lshlrev_b32 v97, 16, v73
v_and_b32 v98, 0xffff0000, v72
v_lshlrev_b32 v99, 16, v72
v_fma_f32 v96, v96, s36, v32
v_fma_f32 v97, v97, s36, v33
v_fma_f32 v98, v98, s36, v34
v_fma_f32 v99, v99, s36, v35
v_cvt_pk_bf16_f32 v112, v96, v97
v_cvt_pk_bf16_f32 v113, v98, v99
buffer_store_dwordx2 v[112:113], v14, s[24:27], 0 offen offset:2048 sc1
s_waitcnt lgkmcnt(2)
v_and_b32 v100, 0xffff0000, v75
v_lshlrev_b32 v101, 16, v75
v_and_b32 v102, 0xffff0000, v74
v_lshlrev_b32 v103, 16, v74
v_fma_f32 v100, v100, s36, v36
v_fma_f32 v101, v101, s36, v37
v_fma_f32 v102, v102, s36, v38
v_fma_f32 v103, v103, s36, v39
v_cvt_pk_bf16_f32 v114, v100, v101
v_cvt_pk_bf16_f32 v115, v102, v103
buffer_store_dwordx2 v[114:115], v14, s[24:27], 0 offen offset:2560 sc1
s_waitcnt lgkmcnt(1)
v_and_b32 v96, 0xffff0000, v77
v_lshlrev_b32 v97, 16, v77
v_and_b32 v98, 0xffff0000, v76
v_lshlrev_b32 v99, 16, v76
v_fma_f32 v96, v96, s36, v40
v_fma_f32 v97, v97, s36, v41
v_fma_f32 v98, v98, s36, v42
v_fma_f32 v99, v99, s36, v43
v_cvt_pk_bf16_f32 v116, v96, v97
v_cvt_pk_bf16_f32 v117, v98, v99
buffer_store_dwordx2 v[116:117], v14, s[24:27], 0 offen offset:3072 sc1
s_waitcnt lgkmcnt(0)
v_and_b32 v100, 0xffff0000, v79
v_lshlrev_b32 v101, 16, v79
v_and_b32 v102, 0xffff0000, v78
v_lshlrev_b32 v103, 16, v78
v_fma_f32 v100, v100, s36, v44
v_fma_f32 v101, v101, s36, v45
v_fma_f32 v102, v102, s36, v46
v_fma_f32 v103, v103, s36, v47
v_cvt_pk_bf16_f32 v118, v100, v101
v_cvt_pk_bf16_f32 v119, v102, v103
buffer_store_dwordx2 v[118:119], v14, s[24:27], 0 offen offset:3584 sc1
s_branch front_kernel_roles_end
front_kernel_bg:
s_cmp_ge_u32 s2, 198
s_cbranch_scc1 front_kernel_rp
s_load_dwordx2 s[4:5], s[0:1], 64
s_load_dwordx2 s[6:7], s[0:1], 112
v_lshrrev_b32 v1, 6, v0
s_nop 0
v_readfirstlane_b32 s12, v1
s_nop 3
s_sub_u32 s13, s2, 144
s_lshl_b32 s13, s13, 2
s_add_u32 s13, s13, s12
v_and_b32 v1, 63, v0
s_mul_i32 s14, s12, 20480
s_waitcnt lgkmcnt(0)
s_add_u32 s16, s4, 0
s_addc_u32 s17, s5, 0
s_and_b32 s17, s17, 0xffff
s_mov_b32 s18, 5308416
s_mov_b32 s19, 0x00020000
s_add_u32 s20, s6, 33685504
s_addc_u32 s21, s7, 0
s_and_b32 s21, s21, 0xffff
s_mov_b32 s22, 5308416
s_mov_b32 s23, 0x00020000
v_lshrrev_b32 v8, 3, v1
v_mul_u32_u24 v8, 9216, v8
v_and_b32 v9, 7, v1
v_lshl_add_u32 v2, v9, 4, v8
v_and_b32 v8, 15, v1
v_lshrrev_b32 v9, 4, v1
v_lshrrev_b32 v10, 2, v8
v_lshl_add_u32 v10, v9, 3, v10
v_lshlrev_b32 v10, 7, v10
v_and_b32 v8, 3, v8
v_lshl_add_u32 v10, v8, 3, v10
v_add_u32 v3, s14, v10
v_lshlrev_b32 v4, 4, v1
s_add_u32 s15, s13, 216
s_mul_i32 s40, s15, 6473
s_lshr_b32 s40, s40, 20
s_mul_i32 s41, s40, 162
s_sub_u32 s41, s15, s41
s_mul_i32 s48, s40, 648
s_add_u32 s48, s48, s41
s_lshl_b32 s48, s48, 10
s_mul_i32 s40, s40, 1152
s_mul_i32 s42, s41, 3641
s_lshr_b32 s42, s42, 16
s_mul_i32 s43, s42, 18
s_sub_u32 s41, s41, s43
s_lshl_b32 s42, s42, 7
s_add_u32 s40, s40, s42
s_mul_i32 s41, s41, 294912
s_add_u32 s40, s40, s41
s_cmp_lt_u32 s15, 1296
s_cselect_b32 s40, s40, 0x70000000
s_cselect_b32 s48, s48, 0x70000000
s_add_u32 m0, s14, 0
s_add_u32 s41, s40, 0
buffer_load_dwordx4 v2, s[16:19], s41 offen nt lds
s_add_u32 m0, s14, 1024
s_add_u32 s41, s40, 73728
buffer_load_dwordx4 v2, s[16:19], s41 offen nt lds
s_add_u32 m0, s14, 2048
s_add_u32 s41, s40, 147456
buffer_load_dwordx4 v2, s[16:19], s41 offen nt lds
s_add_u32 m0, s14, 3072
s_add_u32 s41, s40, 221184
buffer_load_dwordx4 v2, s[16:19], s41 offen nt lds
s_add_u32 s15, s13, 432
s_mul_i32 s40, s15, 6473
s_lshr_b32 s40, s40, 20
s_mul_i32 s41, s40, 162
s_sub_u32 s41, s15, s41
s_mul_i32 s49, s40, 648
s_add_u32 s49, s49, s41
s_lshl_b32 s49, s49, 10
s_mul_i32 s40, s40, 1152
s_mul_i32 s42, s41, 3641
s_lshr_b32 s42, s42, 16
s_mul_i32 s43, s42, 18
s_sub_u32 s41, s41, s43
s_lshl_b32 s42, s42, 7
s_add_u32 s40, s40, s42
s_mul_i32 s41, s41, 294912
s_add_u32 s40, s40, s41
s_cmp_lt_u32 s15, 1296
s_cselect_b32 s40, s40, 0x70000000
s_cselect_b32 s49, s49, 0x70000000
s_add_u32 m0, s14, 4096
s_add_u32 s41, s40, 0
buffer_load_dwordx4 v2, s[16:19], s41 offen nt lds
s_add_u32 m0, s14, 5120
s_add_u32 s41, s40, 73728
buffer_load_dwordx4 v2, s[16:19], s41 offen nt lds
s_add_u32 m0, s14, 6144
s_add_u32 s41, s40, 147456
buffer_load_dwordx4 v2, s[16:19], s41 offen nt lds
s_add_u32 m0, s14, 7168
s_add_u32 s41, s40, 221184
buffer_load_dwordx4 v2, s[16:19], s41 offen nt lds
s_add_u32 s15, s13, 648
s_mul_i32 s40, s15, 6473
s_lshr_b32 s40, s40, 20
s_mul_i32 s41, s40, 162
s_sub_u32 s41, s15, s41
s_mul_i32 s50, s40, 648
s_add_u32 s50, s50, s41
s_lshl_b32 s50, s50, 10
s_mul_i32 s40, s40, 1152
s_mul_i32 s42, s41, 3641
s_lshr_b32 s42, s42, 16
s_mul_i32 s43, s42, 18
s_sub_u32 s41, s41, s43
s_lshl_b32 s42, s42, 7
s_add_u32 s40, s40, s42
s_mul_i32 s41, s41, 294912
s_add_u32 s40, s40, s41
s_cmp_lt_u32 s15, 1296
s_cselect_b32 s40, s40, 0x70000000
s_cselect_b32 s50, s50, 0x70000000
s_add_u32 m0, s14, 8192
s_add_u32 s41, s40, 0
buffer_load_dwordx4 v2, s[16:19], s41 offen nt lds
s_add_u32 m0, s14, 9216
s_add_u32 s41, s40, 73728
buffer_load_dwordx4 v2, s[16:19], s41 offen nt lds
s_add_u32 m0, s14, 10240
s_add_u32 s41, s40, 147456
buffer_load_dwordx4 v2, s[16:19], s41 offen nt lds
s_add_u32 m0, s14, 11264
s_add_u32 s41, s40, 221184
buffer_load_dwordx4 v2, s[16:19], s41 offen nt lds
s_add_u32 s15, s13, 864
s_mul_i32 s40, s15, 6473
s_lshr_b32 s40, s40, 20
s_mul_i32 s41, s40, 162
s_sub_u32 s41, s15, s41
s_mul_i32 s51, s40, 648
s_add_u32 s51, s51, s41
s_lshl_b32 s51, s51, 10
s_mul_i32 s40, s40, 1152
s_mul_i32 s42, s41, 3641
s_lshr_b32 s42, s42, 16
s_mul_i32 s43, s42, 18
s_sub_u32 s41, s41, s43
s_lshl_b32 s42, s42, 7
s_add_u32 s40, s40, s42
s_mul_i32 s41, s41, 294912
s_add_u32 s40, s40, s41
s_cmp_lt_u32 s15, 1296
s_cselect_b32 s40, s40, 0x70000000
s_cselect_b32 s51, s51, 0x70000000
s_add_u32 m0, s14, 12288
s_add_u32 s41, s40, 0
buffer_load_dwordx4 v2, s[16:19], s41 offen nt lds
s_add_u32 m0, s14, 13312
s_add_u32 s41, s40, 73728
buffer_load_dwordx4 v2, s[16:19], s41 offen nt lds
s_add_u32 m0, s14, 14336
s_add_u32 s41, s40, 147456
buffer_load_dwordx4 v2, s[16:19], s41 offen nt lds
s_add_u32 m0, s14, 15360
s_add_u32 s41, s40, 221184
buffer_load_dwordx4 v2, s[16:19], s41 offen nt lds
s_add_u32 s15, s13, 1080
s_mul_i32 s40, s15, 6473
s_lshr_b32 s40, s40, 20
s_mul_i32 s41, s40, 162
s_sub_u32 s41, s15, s41
s_mul_i32 s52, s40, 648
s_add_u32 s52, s52, s41
s_lshl_b32 s52, s52, 10
s_mul_i32 s40, s40, 1152
s_mul_i32 s42, s41, 3641
s_lshr_b32 s42, s42, 16
s_mul_i32 s43, s42, 18
s_sub_u32 s41, s41, s43
s_lshl_b32 s42, s42, 7
s_add_u32 s40, s40, s42
s_mul_i32 s41, s41, 294912
s_add_u32 s40, s40, s41
s_cmp_lt_u32 s15, 1296
s_cselect_b32 s40, s40, 0x70000000
s_cselect_b32 s52, s52, 0x70000000
s_add_u32 m0, s14, 16384
s_add_u32 s41, s40, 0
buffer_load_dwordx4 v2, s[16:19], s41 offen nt lds
s_add_u32 m0, s14, 17408
s_add_u32 s41, s40, 73728
buffer_load_dwordx4 v2, s[16:19], s41 offen nt lds
s_add_u32 m0, s14, 18432
s_add_u32 s41, s40, 147456
buffer_load_dwordx4 v2, s[16:19], s41 offen nt lds
s_add_u32 m0, s14, 19456
s_add_u32 s41, s40, 221184
buffer_load_dwordx4 v2, s[16:19], s41 offen nt lds
s_load_dwordx2 s[32:33], s[0:1], 80
s_load_dwordx2 s[34:35], s[0:1], 88
s_load_dwordx2 s[36:37], s[0:1], 104
s_sub_u32 s38, s2, 144
v_and_b32 v5, 7, v0
v_lshrrev_b32 v6, 3, v0
s_waitcnt lgkmcnt(0)
s_add_u32 s56, s32, 0
s_addc_u32 s57, s33, 0
s_and_b32 s57, s57, 0xffff
s_mov_b32 s58, 1152
s_mov_b32 s59, 0x00020000
s_add_u32 s60, s34, 0
s_addc_u32 s61, s35, 0
s_and_b32 s61, s61, 0xffff
s_mov_b32 s62, 3981312
s_mov_b32 s63, 0x00020000
s_add_u32 s64, s6, 0
s_addc_u32 s65, s7, 0
s_and_b32 s65, s65, 0xffff
s_mov_b32 s66, 13824
s_mov_b32 s67, 0x00020000
v_lshlrev_b32 v7, 1, v0
buffer_load_ushort v8, v7, s[56:59], 0 offen offset:0
buffer_load_ushort v9, v7, s[56:59], 0 offen offset:512
buffer_load_ushort v10, v7, s[56:59], 0 offen offset:1024
v_mul_u32_u24 v11, 6912, v6
v_lshl_add_u32 v11, v5, 4, v11
s_lshl_b32 s39, s38, 7
buffer_load_dwordx4 v[16:19], v11, s[60:63], s39 offen nt
s_add_u32 s39, s39, 221184
buffer_load_dwordx4 v[20:23], v11, s[60:63], s39 offen nt
s_add_u32 s39, s39, 221184
buffer_load_dwordx4 v[24:27], v11, s[60:63], s39 offen nt
s_add_u32 s39, s39, 221184
buffer_load_dwordx4 v[28:31], v11, s[60:63], s39 offen nt
s_add_u32 s39, s39, 221184
buffer_load_dwordx4 v[32:35], v11, s[60:63], s39 offen nt
s_add_u32 s39, s39, 221184
buffer_load_dwordx4 v[36:39], v11, s[60:63], s39 offen nt
s_add_u32 s39, s39, 221184
buffer_load_dwordx4 v[40:43], v11, s[60:63], s39 offen nt
s_add_u32 s39, s39, 221184
buffer_load_dwordx4 v[44:47], v11, s[60:63], s39 offen nt
s_add_u32 s39, s39, 221184
buffer_load_dwordx4 v[48:51], v11, s[60:63], s39 offen nt
s_add_u32 s39, s39, 221184
buffer_load_dwordx4 v[52:55], v11, s[60:63], s39 offen nt
s_add_u32 s39, s39, 221184
buffer_load_dwordx4 v[56:59], v11, s[60:63], s39 offen nt
s_add_u32 s39, s39, 221184
buffer_load_dwordx4 v[60:63], v11, s[60:63], s39 offen nt
s_add_u32 s39, s39, 221184
buffer_load_dwordx4 v[64:67], v11, s[60:63], s39 offen nt
s_add_u32 s39, s39, 221184
buffer_load_dwordx4 v[68:71], v11, s[60:63], s39 offen nt
s_add_u32 s39, s39, 221184
buffer_load_dwordx4 v[72:75], v11, s[60:63], s39 offen nt
s_add_u32 s39, s39, 221184
buffer_load_dwordx4 v[76:79], v11, s[60:63], s39 offen nt
s_add_u32 s39, s39, 221184
buffer_load_dwordx4 v[80:83], v11, s[60:63], s39 offen nt
s_add_u32 s39, s39, 221184
buffer_load_dwordx4 v[84:87], v11, s[60:63], s39 offen nt
s_waitcnt vmcnt(18)
v_lshlrev_b32 v12, 2, v0
v_add_u32 v12, 98304, v12
v_lshlrev_b32 v8, 16, v8
v_mul_f32 v13, 0xbfb8aa3b, v8
v_exp_f32 v13, v13
s_nop 0
v_add_f32 v13, 1.0, v13
v_rcp_f32 v13, v13
s_nop 0
v_mul_f32 v13, v8, v13
v_cvt_pk_bf16_f32 v13, v13, v13
v_lshlrev_b32 v13, 16, v13
ds_write_b32 v12, v13 offset:0
v_lshlrev_b32 v9, 16, v9
v_mul_f32 v13, 0xbfb8aa3b, v9
v_exp_f32 v13, v13
s_nop 0
v_add_f32 v13, 1.0, v13
v_rcp_f32 v13, v13
s_nop 0
v_mul_f32 v13, v9, v13
v_cvt_pk_bf16_f32 v13, v13, v13
v_lshlrev_b32 v13, 16, v13
ds_write_b32 v12, v13 offset:1024
v_lshlrev_b32 v10, 16, v10
v_mul_f32 v13, 0xbfb8aa3b, v10
v_exp_f32 v13, v13
s_nop 0
v_add_f32 v13, 1.0, v13
v_rcp_f32 v13, v13
s_nop 0
v_mul_f32 v13, v10, v13
v_cvt_pk_bf16_f32 v13, v13, v13
v_lshlrev_b32 v13, 16, v13
ds_write_b32 v12, v13 offset:2048
s_waitcnt lgkmcnt(0)
s_barrier
v_lshlrev_b32 v12, 2, v6
v_add_u32 v12, 98304, v12
ds_read_b32 v88, v12 offset:0
ds_read_b32 v89, v12 offset:128
ds_read_b32 v90, v12 offset:256
ds_read_b32 v91, v12 offset:384
ds_read_b32 v92, v12 offset:512
ds_read_b32 v93, v12 offset:640
ds_read_b32 v94, v12 offset:768
ds_read_b32 v95, v12 offset:896
ds_read_b32 v96, v12 offset:1024
ds_read_b32 v97, v12 offset:1152
ds_read_b32 v98, v12 offset:1280
ds_read_b32 v99, v12 offset:1408
ds_read_b32 v100, v12 offset:1536
ds_read_b32 v101, v12 offset:1664
ds_read_b32 v102, v12 offset:1792
ds_read_b32 v103, v12 offset:1920
ds_read_b32 v104, v12 offset:2048
ds_read_b32 v105, v12 offset:2176
v_mov_b32 v108, 0
v_mov_b32 v109, 0
v_mov_b32 v110, 0
v_mov_b32 v111, 0
v_mov_b32 v112, 0
v_mov_b32 v113, 0
v_mov_b32 v114, 0
v_mov_b32 v115, 0
s_waitcnt lgkmcnt(0)
s_waitcnt vmcnt(17)
v_lshlrev_b32 v116, 16, v16
v_and_b32 v117, 0xffff0000, v16
v_fmac_f32 v108, v116, v88
v_fmac_f32 v109, v117, v88
v_lshlrev_b32 v116, 16, v17
v_and_b32 v117, 0xffff0000, v17
v_fmac_f32 v110, v116, v88
v_fmac_f32 v111, v117, v88
v_lshlrev_b32 v116, 16, v18
v_and_b32 v117, 0xffff0000, v18
v_fmac_f32 v112, v116, v88
v_fmac_f32 v113, v117, v88
v_lshlrev_b32 v116, 16, v19
v_and_b32 v117, 0xffff0000, v19
v_fmac_f32 v114, v116, v88
v_fmac_f32 v115, v117, v88
s_waitcnt vmcnt(16)
v_lshlrev_b32 v116, 16, v20
v_and_b32 v117, 0xffff0000, v20
v_fmac_f32 v108, v116, v89
v_fmac_f32 v109, v117, v89
v_lshlrev_b32 v116, 16, v21
v_and_b32 v117, 0xffff0000, v21
v_fmac_f32 v110, v116, v89
v_fmac_f32 v111, v117, v89
v_lshlrev_b32 v116, 16, v22
v_and_b32 v117, 0xffff0000, v22
v_fmac_f32 v112, v116, v89
v_fmac_f32 v113, v117, v89
v_lshlrev_b32 v116, 16, v23
v_and_b32 v117, 0xffff0000, v23
v_fmac_f32 v114, v116, v89
v_fmac_f32 v115, v117, v89
s_waitcnt vmcnt(15)
v_lshlrev_b32 v116, 16, v24
v_and_b32 v117, 0xffff0000, v24
v_fmac_f32 v108, v116, v90
v_fmac_f32 v109, v117, v90
v_lshlrev_b32 v116, 16, v25
v_and_b32 v117, 0xffff0000, v25
v_fmac_f32 v110, v116, v90
v_fmac_f32 v111, v117, v90
v_lshlrev_b32 v116, 16, v26
v_and_b32 v117, 0xffff0000, v26
v_fmac_f32 v112, v116, v90
v_fmac_f32 v113, v117, v90
v_lshlrev_b32 v116, 16, v27
v_and_b32 v117, 0xffff0000, v27
v_fmac_f32 v114, v116, v90
v_fmac_f32 v115, v117, v90
s_waitcnt vmcnt(14)
v_lshlrev_b32 v116, 16, v28
v_and_b32 v117, 0xffff0000, v28
v_fmac_f32 v108, v116, v91
v_fmac_f32 v109, v117, v91
v_lshlrev_b32 v116, 16, v29
v_and_b32 v117, 0xffff0000, v29
v_fmac_f32 v110, v116, v91
v_fmac_f32 v111, v117, v91
v_lshlrev_b32 v116, 16, v30
v_and_b32 v117, 0xffff0000, v30
v_fmac_f32 v112, v116, v91
v_fmac_f32 v113, v117, v91
v_lshlrev_b32 v116, 16, v31
v_and_b32 v117, 0xffff0000, v31
v_fmac_f32 v114, v116, v91
v_fmac_f32 v115, v117, v91
s_waitcnt vmcnt(13)
v_lshlrev_b32 v116, 16, v32
v_and_b32 v117, 0xffff0000, v32
v_fmac_f32 v108, v116, v92
v_fmac_f32 v109, v117, v92
v_lshlrev_b32 v116, 16, v33
v_and_b32 v117, 0xffff0000, v33
v_fmac_f32 v110, v116, v92
v_fmac_f32 v111, v117, v92
v_lshlrev_b32 v116, 16, v34
v_and_b32 v117, 0xffff0000, v34
v_fmac_f32 v112, v116, v92
v_fmac_f32 v113, v117, v92
v_lshlrev_b32 v116, 16, v35
v_and_b32 v117, 0xffff0000, v35
v_fmac_f32 v114, v116, v92
v_fmac_f32 v115, v117, v92
s_waitcnt vmcnt(12)
v_lshlrev_b32 v116, 16, v36
v_and_b32 v117, 0xffff0000, v36
v_fmac_f32 v108, v116, v93
v_fmac_f32 v109, v117, v93
v_lshlrev_b32 v116, 16, v37
v_and_b32 v117, 0xffff0000, v37
v_fmac_f32 v110, v116, v93
v_fmac_f32 v111, v117, v93
v_lshlrev_b32 v116, 16, v38
v_and_b32 v117, 0xffff0000, v38
v_fmac_f32 v112, v116, v93
v_fmac_f32 v113, v117, v93
v_lshlrev_b32 v116, 16, v39
v_and_b32 v117, 0xffff0000, v39
v_fmac_f32 v114, v116, v93
v_fmac_f32 v115, v117, v93
s_waitcnt vmcnt(11)
v_lshlrev_b32 v116, 16, v40
v_and_b32 v117, 0xffff0000, v40
v_fmac_f32 v108, v116, v94
v_fmac_f32 v109, v117, v94
v_lshlrev_b32 v116, 16, v41
v_and_b32 v117, 0xffff0000, v41
v_fmac_f32 v110, v116, v94
v_fmac_f32 v111, v117, v94
v_lshlrev_b32 v116, 16, v42
v_and_b32 v117, 0xffff0000, v42
v_fmac_f32 v112, v116, v94
v_fmac_f32 v113, v117, v94
v_lshlrev_b32 v116, 16, v43
v_and_b32 v117, 0xffff0000, v43
v_fmac_f32 v114, v116, v94
v_fmac_f32 v115, v117, v94
s_waitcnt vmcnt(10)
v_lshlrev_b32 v116, 16, v44
v_and_b32 v117, 0xffff0000, v44
v_fmac_f32 v108, v116, v95
v_fmac_f32 v109, v117, v95
v_lshlrev_b32 v116, 16, v45
v_and_b32 v117, 0xffff0000, v45
v_fmac_f32 v110, v116, v95
v_fmac_f32 v111, v117, v95
v_lshlrev_b32 v116, 16, v46
v_and_b32 v117, 0xffff0000, v46
v_fmac_f32 v112, v116, v95
v_fmac_f32 v113, v117, v95
v_lshlrev_b32 v116, 16, v47
v_and_b32 v117, 0xffff0000, v47
v_fmac_f32 v114, v116, v95
v_fmac_f32 v115, v117, v95
s_waitcnt vmcnt(9)
v_lshlrev_b32 v116, 16, v48
v_and_b32 v117, 0xffff0000, v48
v_fmac_f32 v108, v116, v96
v_fmac_f32 v109, v117, v96
v_lshlrev_b32 v116, 16, v49
v_and_b32 v117, 0xffff0000, v49
v_fmac_f32 v110, v116, v96
v_fmac_f32 v111, v117, v96
v_lshlrev_b32 v116, 16, v50
v_and_b32 v117, 0xffff0000, v50
v_fmac_f32 v112, v116, v96
v_fmac_f32 v113, v117, v96
v_lshlrev_b32 v116, 16, v51
v_and_b32 v117, 0xffff0000, v51
v_fmac_f32 v114, v116, v96
v_fmac_f32 v115, v117, v96
s_waitcnt vmcnt(8)
v_lshlrev_b32 v116, 16, v52
v_and_b32 v117, 0xffff0000, v52
v_fmac_f32 v108, v116, v97
v_fmac_f32 v109, v117, v97
v_lshlrev_b32 v116, 16, v53
v_and_b32 v117, 0xffff0000, v53
v_fmac_f32 v110, v116, v97
v_fmac_f32 v111, v117, v97
v_lshlrev_b32 v116, 16, v54
v_and_b32 v117, 0xffff0000, v54
v_fmac_f32 v112, v116, v97
v_fmac_f32 v113, v117, v97
v_lshlrev_b32 v116, 16, v55
v_and_b32 v117, 0xffff0000, v55
v_fmac_f32 v114, v116, v97
v_fmac_f32 v115, v117, v97
s_waitcnt vmcnt(7)
v_lshlrev_b32 v116, 16, v56
v_and_b32 v117, 0xffff0000, v56
v_fmac_f32 v108, v116, v98
v_fmac_f32 v109, v117, v98
v_lshlrev_b32 v116, 16, v57
v_and_b32 v117, 0xffff0000, v57
v_fmac_f32 v110, v116, v98
v_fmac_f32 v111, v117, v98
v_lshlrev_b32 v116, 16, v58
v_and_b32 v117, 0xffff0000, v58
v_fmac_f32 v112, v116, v98
v_fmac_f32 v113, v117, v98
v_lshlrev_b32 v116, 16, v59
v_and_b32 v117, 0xffff0000, v59
v_fmac_f32 v114, v116, v98
v_fmac_f32 v115, v117, v98
s_waitcnt vmcnt(6)
v_lshlrev_b32 v116, 16, v60
v_and_b32 v117, 0xffff0000, v60
v_fmac_f32 v108, v116, v99
v_fmac_f32 v109, v117, v99
v_lshlrev_b32 v116, 16, v61
v_and_b32 v117, 0xffff0000, v61
v_fmac_f32 v110, v116, v99
v_fmac_f32 v111, v117, v99
v_lshlrev_b32 v116, 16, v62
v_and_b32 v117, 0xffff0000, v62
v_fmac_f32 v112, v116, v99
v_fmac_f32 v113, v117, v99
v_lshlrev_b32 v116, 16, v63
v_and_b32 v117, 0xffff0000, v63
v_fmac_f32 v114, v116, v99
v_fmac_f32 v115, v117, v99
s_waitcnt vmcnt(5)
v_lshlrev_b32 v116, 16, v64
v_and_b32 v117, 0xffff0000, v64
v_fmac_f32 v108, v116, v100
v_fmac_f32 v109, v117, v100
v_lshlrev_b32 v116, 16, v65
v_and_b32 v117, 0xffff0000, v65
v_fmac_f32 v110, v116, v100
v_fmac_f32 v111, v117, v100
v_lshlrev_b32 v116, 16, v66
v_and_b32 v117, 0xffff0000, v66
v_fmac_f32 v112, v116, v100
v_fmac_f32 v113, v117, v100
v_lshlrev_b32 v116, 16, v67
v_and_b32 v117, 0xffff0000, v67
v_fmac_f32 v114, v116, v100
v_fmac_f32 v115, v117, v100
s_waitcnt vmcnt(4)
v_lshlrev_b32 v116, 16, v68
v_and_b32 v117, 0xffff0000, v68
v_fmac_f32 v108, v116, v101
v_fmac_f32 v109, v117, v101
v_lshlrev_b32 v116, 16, v69
v_and_b32 v117, 0xffff0000, v69
v_fmac_f32 v110, v116, v101
v_fmac_f32 v111, v117, v101
v_lshlrev_b32 v116, 16, v70
v_and_b32 v117, 0xffff0000, v70
v_fmac_f32 v112, v116, v101
v_fmac_f32 v113, v117, v101
v_lshlrev_b32 v116, 16, v71
v_and_b32 v117, 0xffff0000, v71
v_fmac_f32 v114, v116, v101
v_fmac_f32 v115, v117, v101
s_waitcnt vmcnt(3)
v_lshlrev_b32 v116, 16, v72
v_and_b32 v117, 0xffff0000, v72
v_fmac_f32 v108, v116, v102
v_fmac_f32 v109, v117, v102
v_lshlrev_b32 v116, 16, v73
v_and_b32 v117, 0xffff0000, v73
v_fmac_f32 v110, v116, v102
v_fmac_f32 v111, v117, v102
v_lshlrev_b32 v116, 16, v74
v_and_b32 v117, 0xffff0000, v74
v_fmac_f32 v112, v116, v102
v_fmac_f32 v113, v117, v102
v_lshlrev_b32 v116, 16, v75
v_and_b32 v117, 0xffff0000, v75
v_fmac_f32 v114, v116, v102
v_fmac_f32 v115, v117, v102
s_waitcnt vmcnt(2)
v_lshlrev_b32 v116, 16, v76
v_and_b32 v117, 0xffff0000, v76
v_fmac_f32 v108, v116, v103
v_fmac_f32 v109, v117, v103
v_lshlrev_b32 v116, 16, v77
v_and_b32 v117, 0xffff0000, v77
v_fmac_f32 v110, v116, v103
v_fmac_f32 v111, v117, v103
v_lshlrev_b32 v116, 16, v78
v_and_b32 v117, 0xffff0000, v78
v_fmac_f32 v112, v116, v103
v_fmac_f32 v113, v117, v103
v_lshlrev_b32 v116, 16, v79
v_and_b32 v117, 0xffff0000, v79
v_fmac_f32 v114, v116, v103
v_fmac_f32 v115, v117, v103
s_waitcnt vmcnt(1)
v_lshlrev_b32 v116, 16, v80
v_and_b32 v117, 0xffff0000, v80
v_fmac_f32 v108, v116, v104
v_fmac_f32 v109, v117, v104
v_lshlrev_b32 v116, 16, v81
v_and_b32 v117, 0xffff0000, v81
v_fmac_f32 v110, v116, v104
v_fmac_f32 v111, v117, v104
v_lshlrev_b32 v116, 16, v82
v_and_b32 v117, 0xffff0000, v82
v_fmac_f32 v112, v116, v104
v_fmac_f32 v113, v117, v104
v_lshlrev_b32 v116, 16, v83
v_and_b32 v117, 0xffff0000, v83
v_fmac_f32 v114, v116, v104
v_fmac_f32 v115, v117, v104
s_waitcnt vmcnt(0)
v_lshlrev_b32 v116, 16, v84
v_and_b32 v117, 0xffff0000, v84
v_fmac_f32 v108, v116, v105
v_fmac_f32 v109, v117, v105
v_lshlrev_b32 v116, 16, v85
v_and_b32 v117, 0xffff0000, v85
v_fmac_f32 v110, v116, v105
v_fmac_f32 v111, v117, v105
v_lshlrev_b32 v116, 16, v86
v_and_b32 v117, 0xffff0000, v86
v_fmac_f32 v112, v116, v105
v_fmac_f32 v113, v117, v105
v_lshlrev_b32 v116, 16, v87
v_and_b32 v117, 0xffff0000, v87
v_fmac_f32 v114, v116, v105
v_fmac_f32 v115, v117, v105
v_lshlrev_b32 v13, 8, v6
v_lshl_add_u32 v13, v5, 5, v13
v_add_u32 v13, 98304, v13
ds_write_b128 v13, v[108:111] offset:3072
ds_write_b128 v13, v[112:115] offset:3088
s_waitcnt lgkmcnt(0)
s_barrier
v_cmp_gt_u32 vcc, 64, v0
s_and_saveexec_b64 s[44:45], vcc
s_cbranch_execz front_kernel_modend
v_lshlrev_b32 v13, 2, v0
v_add_u32 v12, 98304, v13
ds_read_b32 v16, v12 offset:3072
ds_read_b32 v17, v12 offset:3328
ds_read_b32 v18, v12 offset:3584
ds_read_b32 v19, v12 offset:3840
ds_read_b32 v20, v12 offset:4096
ds_read_b32 v21, v12 offset:4352
ds_read_b32 v22, v12 offset:4608
ds_read_b32 v23, v12 offset:4864
ds_read_b32 v24, v12 offset:5120
ds_read_b32 v25, v12 offset:5376
ds_read_b32 v26, v12 offset:5632
ds_read_b32 v27, v12 offset:5888
ds_read_b32 v28, v12 offset:6144
ds_read_b32 v29, v12 offset:6400
ds_read_b32 v30, v12 offset:6656
ds_read_b32 v31, v12 offset:6912
ds_read_b32 v32, v12 offset:7168
ds_read_b32 v33, v12 offset:7424
ds_read_b32 v34, v12 offset:7680
ds_read_b32 v35, v12 offset:7936
ds_read_b32 v36, v12 offset:8192
ds_read_b32 v37, v12 offset:8448
ds_read_b32 v38, v12 offset:8704
ds_read_b32 v39, v12 offset:8960
ds_read_b32 v40, v12 offset:9216
ds_read_b32 v41, v12 offset:9472
ds_read_b32 v42, v12 offset:9728
ds_read_b32 v43, v12 offset:9984
ds_read_b32 v44, v12 offset:10240
ds_read_b32 v45, v12 offset:10496
ds_read_b32 v46, v12 offset:10752
ds_read_b32 v47, v12 offset:11008
s_waitcnt lgkmcnt(0)
v_add_f32 v16, v16, v32
v_add_f32 v17, v17, v33
v_add_f32 v18, v18, v34
v_add_f32 v19, v19, v35
v_add_f32 v20, v20, v36
v_add_f32 v21, v21, v37
v_add_f32 v22, v22, v38
v_add_f32 v23, v23, v39
v_add_f32 v24, v24, v40
v_add_f32 v25, v25, v41
v_add_f32 v26, v26, v42
v_add_f32 v27, v27, v43
v_add_f32 v28, v28, v44
v_add_f32 v29, v29, v45
v_add_f32 v30, v30, v46
v_add_f32 v31, v31, v47
v_add_f32 v16, v16, v24
v_add_f32 v17, v17, v25
v_add_f32 v18, v18, v26
v_add_f32 v19, v19, v27
v_add_f32 v20, v20, v28
v_add_f32 v21, v21, v29
v_add_f32 v22, v22, v30
v_add_f32 v23, v23, v31
v_add_f32 v16, v16, v20
v_add_f32 v17, v17, v21
v_add_f32 v18, v18, v22
v_add_f32 v19, v19, v23
v_add_f32 v16, v16, v18
v_add_f32 v17, v17, v19
v_add_f32 v16, v16, v17
v_cvt_pk_bf16_f32 v16, v16, v16
v_lshlrev_b32 v16, 16, v16
s_mul_i32 s39, s38, 7282
s_lshr_b32 s39, s39, 16
s_cmp_eq_u32 s39, 1
s_cselect_b32 s46, 1, 0
s_cmp_eq_u32 s39, 4
s_cselect_b32 s46, 1, s46
s_cmp_eq_u32 s46, 0
s_cbranch_scc1 front_kernel_mod_store
v_add_f32 v16, 1.0, v16
v_cvt_pk_bf16_f32 v16, v16, v16
v_lshlrev_b32 v16, 16, v16
front_kernel_mod_store:
s_lshl_b32 s39, s38, 8
buffer_store_dword v16, v13, s[64:67], s39 offen sc1
front_kernel_modend:
s_mov_b64 exec, s[44:45]
s_waitcnt vmcnt(16)
ds_read_b64_tr_b16 v[16:17], v3 offset:0
ds_read_b64_tr_b16 v[18:19], v3 offset:512
ds_read_b64_tr_b16 v[20:21], v3 offset:32
ds_read_b64_tr_b16 v[22:23], v3 offset:544
ds_read_b64_tr_b16 v[24:25], v3 offset:64
ds_read_b64_tr_b16 v[26:27], v3 offset:576
ds_read_b64_tr_b16 v[28:29], v3 offset:96
ds_read_b64_tr_b16 v[30:31], v3 offset:608
s_waitcnt lgkmcnt(6)
s_add_u32 s40, s48, 0
buffer_store_dwordx4 v[16:19], v4, s[20:23], s40 offen sc1
s_waitcnt lgkmcnt(4)
s_add_u32 s40, s48, 165888
buffer_store_dwordx4 v[20:23], v4, s[20:23], s40 offen sc1
s_waitcnt lgkmcnt(2)
s_add_u32 s40, s48, 331776
buffer_store_dwordx4 v[24:27], v4, s[20:23], s40 offen sc1
s_waitcnt lgkmcnt(0)
s_add_u32 s40, s48, 497664
buffer_store_dwordx4 v[28:31], v4, s[20:23], s40 offen sc1
s_waitcnt vmcnt(16)
ds_read_b64_tr_b16 v[32:33], v3 offset:4096
ds_read_b64_tr_b16 v[34:35], v3 offset:4608
ds_read_b64_tr_b16 v[36:37], v3 offset:4128
ds_read_b64_tr_b16 v[38:39], v3 offset:4640
ds_read_b64_tr_b16 v[40:41], v3 offset:4160
ds_read_b64_tr_b16 v[42:43], v3 offset:4672
ds_read_b64_tr_b16 v[44:45], v3 offset:4192
ds_read_b64_tr_b16 v[46:47], v3 offset:4704
s_waitcnt lgkmcnt(6)
s_add_u32 s40, s49, 0
buffer_store_dwordx4 v[32:35], v4, s[20:23], s40 offen sc1
s_waitcnt lgkmcnt(4)
s_add_u32 s40, s49, 165888
buffer_store_dwordx4 v[36:39], v4, s[20:23], s40 offen sc1
s_waitcnt lgkmcnt(2)
s_add_u32 s40, s49, 331776
buffer_store_dwordx4 v[40:43], v4, s[20:23], s40 offen sc1
s_waitcnt lgkmcnt(0)
s_add_u32 s40, s49, 497664
buffer_store_dwordx4 v[44:47], v4, s[20:23], s40 offen sc1
s_waitcnt vmcnt(16)
ds_read_b64_tr_b16 v[16:17], v3 offset:8192
ds_read_b64_tr_b16 v[18:19], v3 offset:8704
ds_read_b64_tr_b16 v[20:21], v3 offset:8224
ds_read_b64_tr_b16 v[22:23], v3 offset:8736
ds_read_b64_tr_b16 v[24:25], v3 offset:8256
ds_read_b64_tr_b16 v[26:27], v3 offset:8768
ds_read_b64_tr_b16 v[28:29], v3 offset:8288
ds_read_b64_tr_b16 v[30:31], v3 offset:8800
s_waitcnt lgkmcnt(6)
s_add_u32 s40, s50, 0
buffer_store_dwordx4 v[16:19], v4, s[20:23], s40 offen sc1
s_waitcnt lgkmcnt(4)
s_add_u32 s40, s50, 165888
buffer_store_dwordx4 v[20:23], v4, s[20:23], s40 offen sc1
s_waitcnt lgkmcnt(2)
s_add_u32 s40, s50, 331776
buffer_store_dwordx4 v[24:27], v4, s[20:23], s40 offen sc1
s_waitcnt lgkmcnt(0)
s_add_u32 s40, s50, 497664
buffer_store_dwordx4 v[28:31], v4, s[20:23], s40 offen sc1
s_waitcnt vmcnt(16)
ds_read_b64_tr_b16 v[32:33], v3 offset:12288
ds_read_b64_tr_b16 v[34:35], v3 offset:12800
ds_read_b64_tr_b16 v[36:37], v3 offset:12320
ds_read_b64_tr_b16 v[38:39], v3 offset:12832
ds_read_b64_tr_b16 v[40:41], v3 offset:12352
ds_read_b64_tr_b16 v[42:43], v3 offset:12864
ds_read_b64_tr_b16 v[44:45], v3 offset:12384
ds_read_b64_tr_b16 v[46:47], v3 offset:12896
s_waitcnt lgkmcnt(6)
s_add_u32 s40, s51, 0
buffer_store_dwordx4 v[32:35], v4, s[20:23], s40 offen sc1
s_waitcnt lgkmcnt(4)
s_add_u32 s40, s51, 165888
buffer_store_dwordx4 v[36:39], v4, s[20:23], s40 offen sc1
s_waitcnt lgkmcnt(2)
s_add_u32 s40, s51, 331776
buffer_store_dwordx4 v[40:43], v4, s[20:23], s40 offen sc1
s_waitcnt lgkmcnt(0)
s_add_u32 s40, s51, 497664
buffer_store_dwordx4 v[44:47], v4, s[20:23], s40 offen sc1
s_waitcnt vmcnt(16)
ds_read_b64_tr_b16 v[16:17], v3 offset:16384
ds_read_b64_tr_b16 v[18:19], v3 offset:16896
ds_read_b64_tr_b16 v[20:21], v3 offset:16416
ds_read_b64_tr_b16 v[22:23], v3 offset:16928
ds_read_b64_tr_b16 v[24:25], v3 offset:16448
ds_read_b64_tr_b16 v[26:27], v3 offset:16960
ds_read_b64_tr_b16 v[28:29], v3 offset:16480
ds_read_b64_tr_b16 v[30:31], v3 offset:16992
s_waitcnt lgkmcnt(6)
s_add_u32 s40, s52, 0
buffer_store_dwordx4 v[16:19], v4, s[20:23], s40 offen sc1
s_waitcnt lgkmcnt(4)
s_add_u32 s40, s52, 165888
buffer_store_dwordx4 v[20:23], v4, s[20:23], s40 offen sc1
s_waitcnt lgkmcnt(2)
s_add_u32 s40, s52, 331776
buffer_store_dwordx4 v[24:27], v4, s[20:23], s40 offen sc1
s_waitcnt lgkmcnt(0)
s_add_u32 s40, s52, 497664
buffer_store_dwordx4 v[28:31], v4, s[20:23], s40 offen sc1
s_branch front_kernel_roles_end
front_kernel_rp:
s_cmp_lg_u32 s2, 251
s_cbranch_scc1 front_kernel_noflags
s_load_dwordx2 s[32:33], s[0:1], 112
s_load_dwordx2 s[36:37], s[0:1], 104
s_waitcnt lgkmcnt(0)
s_add_u32 s68, s32, 44302336
s_addc_u32 s69, s33, 0
s_and_b32 s69, s69, 0xffff
s_mov_b32 s70, 24576
s_mov_b32 s71, 0x00020000
s_add_u32 s76, s36, 0
s_addc_u32 s77, s37, 0
s_and_b32 s77, s77, 0xffff
s_mov_b32 s78, 256
s_mov_b32 s79, 0x00020000
v_lshlrev_b32 v5, 4, v0
v_mov_b32 v8, 0
v_mov_b32 v9, 0
v_mov_b32 v10, 0
v_mov_b32 v11, 0
buffer_store_dwordx4 v[8:11], v5, s[68:71], 0 offen sc1
v_add_u32 v5, 0x1000, v5
buffer_store_dwordx4 v[8:11], v5, s[68:71], 0 offen sc1
v_add_u32 v5, 0x1000, v5
buffer_store_dwordx4 v[8:11], v5, s[68:71], 0 offen sc1
v_add_u32 v5, 0x1000, v5
buffer_store_dwordx4 v[8:11], v5, s[68:71], 0 offen sc1
v_add_u32 v5, 0x1000, v5
buffer_store_dwordx4 v[8:11], v5, s[68:71], 0 offen sc1
v_add_u32 v5, 0x1000, v5
buffer_store_dwordx4 v[8:11], v5, s[68:71], 0 offen sc1
s_waitcnt vmcnt(0)
s_barrier
v_mov_b32 v5, 0
v_mov_b32 v6, 1
v_cmp_eq_u32 vcc, 0, v0
s_and_saveexec_b64 s[44:45], vcc
s_cbranch_execz front_kernel_noinit
buffer_store_dword v6, v5, s[76:79], 0 offen sc1
front_kernel_noinit:
s_mov_b64 exec, s[44:45]
front_kernel_noflags:
s_load_dwordx2 s[4:5], s[0:1], 56
s_load_dwordx2 s[8:9], s[0:1], 64
s_load_dwordx2 s[6:7], s[0:1], 112
v_lshrrev_b32 v1, 6, v0
s_nop 0
v_readfirstlane_b32 s12, v1
s_nop 3
s_sub_u32 s13, s2, 198
s_lshl_b32 s13, s13, 2
s_add_u32 s13, s13, s12
v_and_b32 v1, 63, v0
s_mul_i32 s14, s12, 28672
s_waitcnt lgkmcnt(0)
s_add_u32 s16, s4, 0
s_addc_u32 s17, s5, 0
s_and_b32 s17, s17, 0xffff
s_mov_b32 s18, 5308416
s_mov_b32 s19, 0x00020000
s_add_u32 s20, s6, 28377088
s_addc_u32 s21, s7, 0
s_and_b32 s21, s21, 0xffff
s_mov_b32 s22, 5308416
s_mov_b32 s23, 0x00020000
v_lshrrev_b32 v8, 3, v1
v_mul_u32_u24 v8, 9216, v8
v_and_b32 v9, 7, v1
v_lshl_add_u32 v2, v9, 4, v8
v_and_b32 v8, 15, v1
v_lshrrev_b32 v9, 4, v1
v_lshrrev_b32 v10, 2, v8
v_lshl_add_u32 v10, v9, 3, v10
v_lshlrev_b32 v10, 7, v10
v_and_b32 v8, 3, v8
v_lshl_add_u32 v10, v8, 3, v10
v_add_u32 v3, s14, v10
v_lshlrev_b32 v4, 4, v1
s_add_u32 s24, s8, 0
s_addc_u32 s25, s9, 0
s_and_b32 s25, s25, 0xffff
s_mov_b32 s26, 5308416
s_mov_b32 s27, 0x00020000
s_add_u32 s28, s6, 33685504
s_addc_u32 s29, s7, 0
s_and_b32 s29, s29, 0xffff
s_mov_b32 s30, 5308416
s_mov_b32 s31, 0x00020000
v_lshrrev_b32 v8, 3, v1
v_mul_u32_u24 v8, 9216, v8
v_and_b32 v9, 7, v1
v_lshl_add_u32 v2, v9, 4, v8
v_and_b32 v8, 15, v1
v_lshrrev_b32 v9, 4, v1
v_lshrrev_b32 v10, 2, v8
v_lshl_add_u32 v10, v9, 3, v10
v_lshlrev_b32 v10, 7, v10
v_and_b32 v8, 3, v8
v_lshl_add_u32 v10, v8, 3, v10
v_add_u32 v3, s14, v10
v_lshlrev_b32 v4, 4, v1
s_add_u32 s15, s13, 0
s_mul_i32 s40, s15, 6473
s_lshr_b32 s40, s40, 20
s_mul_i32 s41, s40, 162
s_sub_u32 s41, s15, s41
s_mul_i32 s48, s40, 648
s_add_u32 s48, s48, s41
s_lshl_b32 s48, s48, 10
s_mul_i32 s40, s40, 1152
s_mul_i32 s42, s41, 3641
s_lshr_b32 s42, s42, 16
s_mul_i32 s43, s42, 18
s_sub_u32 s41, s41, s43
s_lshl_b32 s42, s42, 7
s_add_u32 s40, s40, s42
s_mul_i32 s41, s41, 294912
s_add_u32 s40, s40, s41
s_cmp_lt_u32 s15, 1296
s_cselect_b32 s40, s40, 0x70000000
s_cselect_b32 s48, s48, 0x70000000
s_add_u32 m0, s14, 0
s_add_u32 s41, s40, 0
buffer_load_dwordx4 v2, s[16:19], s41 offen nt lds
s_add_u32 m0, s14, 1024
s_add_u32 s41, s40, 73728
buffer_load_dwordx4 v2, s[16:19], s41 offen nt lds
s_add_u32 m0, s14, 2048
s_add_u32 s41, s40, 147456
buffer_load_dwordx4 v2, s[16:19], s41 offen nt lds
s_add_u32 m0, s14, 3072
s_add_u32 s41, s40, 221184
buffer_load_dwordx4 v2, s[16:19], s41 offen nt lds
s_add_u32 s15, s13, 216
s_mul_i32 s40, s15, 6473
s_lshr_b32 s40, s40, 20
s_mul_i32 s41, s40, 162
s_sub_u32 s41, s15, s41
s_mul_i32 s49, s40, 648
s_add_u32 s49, s49, s41
s_lshl_b32 s49, s49, 10
s_mul_i32 s40, s40, 1152
s_mul_i32 s42, s41, 3641
s_lshr_b32 s42, s42, 16
s_mul_i32 s43, s42, 18
s_sub_u32 s41, s41, s43
s_lshl_b32 s42, s42, 7
s_add_u32 s40, s40, s42
s_mul_i32 s41, s41, 294912
s_add_u32 s40, s40, s41
s_cmp_lt_u32 s15, 1296
s_cselect_b32 s40, s40, 0x70000000
s_cselect_b32 s49, s49, 0x70000000
s_add_u32 m0, s14, 4096
s_add_u32 s41, s40, 0
buffer_load_dwordx4 v2, s[16:19], s41 offen nt lds
s_add_u32 m0, s14, 5120
s_add_u32 s41, s40, 73728
buffer_load_dwordx4 v2, s[16:19], s41 offen nt lds
s_add_u32 m0, s14, 6144
s_add_u32 s41, s40, 147456
buffer_load_dwordx4 v2, s[16:19], s41 offen nt lds
s_add_u32 m0, s14, 7168
s_add_u32 s41, s40, 221184
buffer_load_dwordx4 v2, s[16:19], s41 offen nt lds
s_add_u32 s15, s13, 432
s_mul_i32 s40, s15, 6473
s_lshr_b32 s40, s40, 20
s_mul_i32 s41, s40, 162
s_sub_u32 s41, s15, s41
s_mul_i32 s50, s40, 648
s_add_u32 s50, s50, s41
s_lshl_b32 s50, s50, 10
s_mul_i32 s40, s40, 1152
s_mul_i32 s42, s41, 3641
s_lshr_b32 s42, s42, 16
s_mul_i32 s43, s42, 18
s_sub_u32 s41, s41, s43
s_lshl_b32 s42, s42, 7
s_add_u32 s40, s40, s42
s_mul_i32 s41, s41, 294912
s_add_u32 s40, s40, s41
s_cmp_lt_u32 s15, 1296
s_cselect_b32 s40, s40, 0x70000000
s_cselect_b32 s50, s50, 0x70000000
s_add_u32 m0, s14, 8192
s_add_u32 s41, s40, 0
buffer_load_dwordx4 v2, s[16:19], s41 offen nt lds
s_add_u32 m0, s14, 9216
s_add_u32 s41, s40, 73728
buffer_load_dwordx4 v2, s[16:19], s41 offen nt lds
s_add_u32 m0, s14, 10240
s_add_u32 s41, s40, 147456
buffer_load_dwordx4 v2, s[16:19], s41 offen nt lds
s_add_u32 m0, s14, 11264
s_add_u32 s41, s40, 221184
buffer_load_dwordx4 v2, s[16:19], s41 offen nt lds
s_add_u32 s15, s13, 648
s_mul_i32 s40, s15, 6473
s_lshr_b32 s40, s40, 20
s_mul_i32 s41, s40, 162
s_sub_u32 s41, s15, s41
s_mul_i32 s51, s40, 648
s_add_u32 s51, s51, s41
s_lshl_b32 s51, s51, 10
s_mul_i32 s40, s40, 1152
s_mul_i32 s42, s41, 3641
s_lshr_b32 s42, s42, 16
s_mul_i32 s43, s42, 18
s_sub_u32 s41, s41, s43
s_lshl_b32 s42, s42, 7
s_add_u32 s40, s40, s42
s_mul_i32 s41, s41, 294912
s_add_u32 s40, s40, s41
s_cmp_lt_u32 s15, 1296
s_cselect_b32 s40, s40, 0x70000000
s_cselect_b32 s51, s51, 0x70000000
s_add_u32 m0, s14, 12288
s_add_u32 s41, s40, 0
buffer_load_dwordx4 v2, s[16:19], s41 offen nt lds
s_add_u32 m0, s14, 13312
s_add_u32 s41, s40, 73728
buffer_load_dwordx4 v2, s[16:19], s41 offen nt lds
s_add_u32 m0, s14, 14336
s_add_u32 s41, s40, 147456
buffer_load_dwordx4 v2, s[16:19], s41 offen nt lds
s_add_u32 m0, s14, 15360
s_add_u32 s41, s40, 221184
buffer_load_dwordx4 v2, s[16:19], s41 offen nt lds
s_add_u32 s15, s13, 864
s_mul_i32 s40, s15, 6473
s_lshr_b32 s40, s40, 20
s_mul_i32 s41, s40, 162
s_sub_u32 s41, s15, s41
s_mul_i32 s52, s40, 648
s_add_u32 s52, s52, s41
s_lshl_b32 s52, s52, 10
s_mul_i32 s40, s40, 1152
s_mul_i32 s42, s41, 3641
s_lshr_b32 s42, s42, 16
s_mul_i32 s43, s42, 18
s_sub_u32 s41, s41, s43
s_lshl_b32 s42, s42, 7
s_add_u32 s40, s40, s42
s_mul_i32 s41, s41, 294912
s_add_u32 s40, s40, s41
s_cmp_lt_u32 s15, 1296
s_cselect_b32 s40, s40, 0x70000000
s_cselect_b32 s52, s52, 0x70000000
s_add_u32 m0, s14, 16384
s_add_u32 s41, s40, 0
buffer_load_dwordx4 v2, s[16:19], s41 offen nt lds
s_add_u32 m0, s14, 17408
s_add_u32 s41, s40, 73728
buffer_load_dwordx4 v2, s[16:19], s41 offen nt lds
s_add_u32 m0, s14, 18432
s_add_u32 s41, s40, 147456
buffer_load_dwordx4 v2, s[16:19], s41 offen nt lds
s_add_u32 m0, s14, 19456
s_add_u32 s41, s40, 221184
buffer_load_dwordx4 v2, s[16:19], s41 offen nt lds
s_add_u32 s15, s13, 1080
s_mul_i32 s40, s15, 6473
s_lshr_b32 s40, s40, 20
s_mul_i32 s41, s40, 162
s_sub_u32 s41, s15, s41
s_mul_i32 s53, s40, 648
s_add_u32 s53, s53, s41
s_lshl_b32 s53, s53, 10
s_mul_i32 s40, s40, 1152
s_mul_i32 s42, s41, 3641
s_lshr_b32 s42, s42, 16
s_mul_i32 s43, s42, 18
s_sub_u32 s41, s41, s43
s_lshl_b32 s42, s42, 7
s_add_u32 s40, s40, s42
s_mul_i32 s41, s41, 294912
s_add_u32 s40, s40, s41
s_cmp_lt_u32 s15, 1296
s_cselect_b32 s40, s40, 0x70000000
s_cselect_b32 s53, s53, 0x70000000
s_add_u32 m0, s14, 20480
s_add_u32 s41, s40, 0
buffer_load_dwordx4 v2, s[16:19], s41 offen nt lds
s_add_u32 m0, s14, 21504
s_add_u32 s41, s40, 73728
buffer_load_dwordx4 v2, s[16:19], s41 offen nt lds
s_add_u32 m0, s14, 22528
s_add_u32 s41, s40, 147456
buffer_load_dwordx4 v2, s[16:19], s41 offen nt lds
s_add_u32 m0, s14, 23552
s_add_u32 s41, s40, 221184
buffer_load_dwordx4 v2, s[16:19], s41 offen nt lds
s_add_u32 s15, s13, 0
s_mul_i32 s40, s15, 6473
s_lshr_b32 s40, s40, 20
s_mul_i32 s41, s40, 162
s_sub_u32 s41, s15, s41
s_mul_i32 s54, s40, 648
s_add_u32 s54, s54, s41
s_lshl_b32 s54, s54, 10
s_mul_i32 s40, s40, 1152
s_mul_i32 s42, s41, 3641
s_lshr_b32 s42, s42, 16
s_mul_i32 s43, s42, 18
s_sub_u32 s41, s41, s43
s_lshl_b32 s42, s42, 7
s_add_u32 s40, s40, s42
s_mul_i32 s41, s41, 294912
s_add_u32 s40, s40, s41
s_cmp_lt_u32 s15, 1296
s_cselect_b32 s40, s40, 0x70000000
s_cselect_b32 s54, s54, 0x70000000
s_add_u32 m0, s14, 24576
s_add_u32 s41, s40, 0
buffer_load_dwordx4 v2, s[24:27], s41 offen nt lds
s_add_u32 m0, s14, 25600
s_add_u32 s41, s40, 73728
buffer_load_dwordx4 v2, s[24:27], s41 offen nt lds
s_add_u32 m0, s14, 26624
s_add_u32 s41, s40, 147456
buffer_load_dwordx4 v2, s[24:27], s41 offen nt lds
s_add_u32 m0, s14, 27648
s_add_u32 s41, s40, 221184
buffer_load_dwordx4 v2, s[24:27], s41 offen nt lds
s_waitcnt vmcnt(24)
ds_read_b64_tr_b16 v[16:17], v3 offset:0
ds_read_b64_tr_b16 v[18:19], v3 offset:512
ds_read_b64_tr_b16 v[20:21], v3 offset:32
ds_read_b64_tr_b16 v[22:23], v3 offset:544
ds_read_b64_tr_b16 v[24:25], v3 offset:64
ds_read_b64_tr_b16 v[26:27], v3 offset:576
ds_read_b64_tr_b16 v[28:29], v3 offset:96
ds_read_b64_tr_b16 v[30:31], v3 offset:608
s_waitcnt lgkmcnt(6)
s_add_u32 s40, s48, 0
buffer_store_dwordx4 v[16:19], v4, s[20:23], s40 offen sc1
s_waitcnt lgkmcnt(4)
s_add_u32 s40, s48, 165888
buffer_store_dwordx4 v[20:23], v4, s[20:23], s40 offen sc1
s_waitcnt lgkmcnt(2)
s_add_u32 s40, s48, 331776
buffer_store_dwordx4 v[24:27], v4, s[20:23], s40 offen sc1
s_waitcnt lgkmcnt(0)
s_add_u32 s40, s48, 497664
buffer_store_dwordx4 v[28:31], v4, s[20:23], s40 offen sc1
s_waitcnt vmcnt(24)
ds_read_b64_tr_b16 v[32:33], v3 offset:4096
ds_read_b64_tr_b16 v[34:35], v3 offset:4608
ds_read_b64_tr_b16 v[36:37], v3 offset:4128
ds_read_b64_tr_b16 v[38:39], v3 offset:4640
ds_read_b64_tr_b16 v[40:41], v3 offset:4160
ds_read_b64_tr_b16 v[42:43], v3 offset:4672
ds_read_b64_tr_b16 v[44:45], v3 offset:4192
ds_read_b64_tr_b16 v[46:47], v3 offset:4704
s_waitcnt lgkmcnt(6)
s_add_u32 s40, s49, 0
buffer_store_dwordx4 v[32:35], v4, s[20:23], s40 offen sc1
s_waitcnt lgkmcnt(4)
s_add_u32 s40, s49, 165888
buffer_store_dwordx4 v[36:39], v4, s[20:23], s40 offen sc1
s_waitcnt lgkmcnt(2)
s_add_u32 s40, s49, 331776
buffer_store_dwordx4 v[40:43], v4, s[20:23], s40 offen sc1
s_waitcnt lgkmcnt(0)
s_add_u32 s40, s49, 497664
buffer_store_dwordx4 v[44:47], v4, s[20:23], s40 offen sc1
s_waitcnt vmcnt(24)
ds_read_b64_tr_b16 v[16:17], v3 offset:8192
ds_read_b64_tr_b16 v[18:19], v3 offset:8704
ds_read_b64_tr_b16 v[20:21], v3 offset:8224
ds_read_b64_tr_b16 v[22:23], v3 offset:8736
ds_read_b64_tr_b16 v[24:25], v3 offset:8256
ds_read_b64_tr_b16 v[26:27], v3 offset:8768
ds_read_b64_tr_b16 v[28:29], v3 offset:8288
ds_read_b64_tr_b16 v[30:31], v3 offset:8800
s_waitcnt lgkmcnt(6)
s_add_u32 s40, s50, 0
buffer_store_dwordx4 v[16:19], v4, s[20:23], s40 offen sc1
s_waitcnt lgkmcnt(4)
s_add_u32 s40, s50, 165888
buffer_store_dwordx4 v[20:23], v4, s[20:23], s40 offen sc1
s_waitcnt lgkmcnt(2)
s_add_u32 s40, s50, 331776
buffer_store_dwordx4 v[24:27], v4, s[20:23], s40 offen sc1
s_waitcnt lgkmcnt(0)
s_add_u32 s40, s50, 497664
buffer_store_dwordx4 v[28:31], v4, s[20:23], s40 offen sc1
s_waitcnt vmcnt(24)
ds_read_b64_tr_b16 v[32:33], v3 offset:12288
ds_read_b64_tr_b16 v[34:35], v3 offset:12800
ds_read_b64_tr_b16 v[36:37], v3 offset:12320
ds_read_b64_tr_b16 v[38:39], v3 offset:12832
ds_read_b64_tr_b16 v[40:41], v3 offset:12352
ds_read_b64_tr_b16 v[42:43], v3 offset:12864
ds_read_b64_tr_b16 v[44:45], v3 offset:12384
ds_read_b64_tr_b16 v[46:47], v3 offset:12896
s_waitcnt lgkmcnt(6)
s_add_u32 s40, s51, 0
buffer_store_dwordx4 v[32:35], v4, s[20:23], s40 offen sc1
s_waitcnt lgkmcnt(4)
s_add_u32 s40, s51, 165888
buffer_store_dwordx4 v[36:39], v4, s[20:23], s40 offen sc1
s_waitcnt lgkmcnt(2)
s_add_u32 s40, s51, 331776
buffer_store_dwordx4 v[40:43], v4, s[20:23], s40 offen sc1
s_waitcnt lgkmcnt(0)
s_add_u32 s40, s51, 497664
buffer_store_dwordx4 v[44:47], v4, s[20:23], s40 offen sc1
s_waitcnt vmcnt(24)
ds_read_b64_tr_b16 v[16:17], v3 offset:16384
ds_read_b64_tr_b16 v[18:19], v3 offset:16896
ds_read_b64_tr_b16 v[20:21], v3 offset:16416
ds_read_b64_tr_b16 v[22:23], v3 offset:16928
ds_read_b64_tr_b16 v[24:25], v3 offset:16448
ds_read_b64_tr_b16 v[26:27], v3 offset:16960
ds_read_b64_tr_b16 v[28:29], v3 offset:16480
ds_read_b64_tr_b16 v[30:31], v3 offset:16992
s_waitcnt lgkmcnt(6)
s_add_u32 s40, s52, 0
buffer_store_dwordx4 v[16:19], v4, s[20:23], s40 offen sc1
s_waitcnt lgkmcnt(4)
s_add_u32 s40, s52, 165888
buffer_store_dwordx4 v[20:23], v4, s[20:23], s40 offen sc1
s_waitcnt lgkmcnt(2)
s_add_u32 s40, s52, 331776
buffer_store_dwordx4 v[24:27], v4, s[20:23], s40 offen sc1
s_waitcnt lgkmcnt(0)
s_add_u32 s40, s52, 497664
buffer_store_dwordx4 v[28:31], v4, s[20:23], s40 offen sc1
s_waitcnt vmcnt(24)
ds_read_b64_tr_b16 v[32:33], v3 offset:20480
ds_read_b64_tr_b16 v[34:35], v3 offset:20992
ds_read_b64_tr_b16 v[36:37], v3 offset:20512
ds_read_b64_tr_b16 v[38:39], v3 offset:21024
ds_read_b64_tr_b16 v[40:41], v3 offset:20544
ds_read_b64_tr_b16 v[42:43], v3 offset:21056
ds_read_b64_tr_b16 v[44:45], v3 offset:20576
ds_read_b64_tr_b16 v[46:47], v3 offset:21088
s_waitcnt lgkmcnt(6)
s_add_u32 s40, s53, 0
buffer_store_dwordx4 v[32:35], v4, s[20:23], s40 offen sc1
s_waitcnt lgkmcnt(4)
s_add_u32 s40, s53, 165888
buffer_store_dwordx4 v[36:39], v4, s[20:23], s40 offen sc1
s_waitcnt lgkmcnt(2)
s_add_u32 s40, s53, 331776
buffer_store_dwordx4 v[40:43], v4, s[20:23], s40 offen sc1
s_waitcnt lgkmcnt(0)
s_add_u32 s40, s53, 497664
buffer_store_dwordx4 v[44:47], v4, s[20:23], s40 offen sc1
s_waitcnt vmcnt(24)
ds_read_b64_tr_b16 v[16:17], v3 offset:24576
ds_read_b64_tr_b16 v[18:19], v3 offset:25088
ds_read_b64_tr_b16 v[20:21], v3 offset:24608
ds_read_b64_tr_b16 v[22:23], v3 offset:25120
ds_read_b64_tr_b16 v[24:25], v3 offset:24640
ds_read_b64_tr_b16 v[26:27], v3 offset:25152
ds_read_b64_tr_b16 v[28:29], v3 offset:24672
ds_read_b64_tr_b16 v[30:31], v3 offset:25184
s_waitcnt lgkmcnt(6)
s_add_u32 s40, s54, 0
buffer_store_dwordx4 v[16:19], v4, s[28:31], s40 offen sc1
s_waitcnt lgkmcnt(4)
s_add_u32 s40, s54, 165888
buffer_store_dwordx4 v[20:23], v4, s[28:31], s40 offen sc1
s_waitcnt lgkmcnt(2)
s_add_u32 s40, s54, 331776
buffer_store_dwordx4 v[24:27], v4, s[28:31], s40 offen sc1
s_waitcnt lgkmcnt(0)
s_add_u32 s40, s54, 497664
buffer_store_dwordx4 v[28:31], v4, s[28:31], s40 offen sc1
front_kernel_roles_end:
front_kernel_done:
s_endpgm

.text
.globl ffn_kernel
.p2align 8
.type ffn_kernel,@function
ffn_kernel:
s_cmp_ge_u32 s2, 256
s_cbranch_scc1 ffn_kernel_done
s_load_dwordx2 s[46:47], s[0:1], 112
s_load_dwordx2 s[44:45], s[0:1], 72
s_load_dwordx2 s[42:43], s[0:1], 0
v_lshrrev_b32 v1, 6, v0
s_nop 0
v_readfirstlane_b32 s28, v1
s_nop 3
s_and_b32 s48, s2, 7
s_lshr_b32 s49, s2, 3
s_and_b32 s50, s48, 3
s_lshl_b32 s50, s50, 1
s_and_b32 s51, s49, 1
s_add_u32 s30, s50, s51
s_lshr_b32 s50, s49, 1
s_lshl_b32 s50, s50, 1
s_lshr_b32 s51, s48, 2
s_add_u32 s29, s50, s51
v_and_b32 v1, 63, v0
v_lshlrev_b32 v4, 4, v1
s_lshl_b32 s48, s48, 8
s_lshl_b32 s49, s49, 3
s_add_u32 s41, s48, s49
s_waitcnt lgkmcnt(0)
v_and_b32 v2, 7, v1
v_lshrrev_b32 v3, 3, v1
s_add_u32 s60, s42, 0
s_addc_u32 s61, s43, 0
s_and_b32 s61, s61, 0xffff
s_mov_b32 s62, 2359296
s_mov_b32 s63, 0x00020000
s_add_u32 s64, s46, 2424832
s_addc_u32 s65, s47, 0
s_and_b32 s65, s65, 0xffff
s_mov_b32 s66, 2359296
s_mov_b32 s67, 0x00020000
s_add_u32 s68, s46, 0
s_addc_u32 s69, s47, 0
s_and_b32 s69, s69, 0xffff
s_mov_b32 s70, 13824
s_mov_b32 s71, 0x00020000
v_mul_u32_u24 v204, 1152, v2
v_lshl_add_u32 v204, v3, 4, v204
s_mul_i32 s49, s41, 1152
s_add_u32 s48, s28, 0
s_mul_i32 s72, s48, 128
s_add_u32 s72, s72, s49
s_cmp_lt_u32 s48, 9
s_cselect_b32 s72, s72, 0x70000000
s_add_u32 s48, s28, 4
s_mul_i32 s73, s48, 128
s_add_u32 s73, s73, s49
s_cmp_lt_u32 s48, 9
s_cselect_b32 s73, s73, 0x70000000
s_add_u32 s48, s28, 8
s_mul_i32 s74, s48, 128
s_add_u32 s74, s74, s49
s_cmp_lt_u32 s48, 9
s_cselect_b32 s74, s74, 0x70000000
v_lshlrev_b32 v205, 12, v1
s_mul_i32 s48, s28, 3072
s_add_u32 s75, s48, 90112
s_lshl_b32 s49, s41, 1
s_lshl_b32 s48, s28, 18
s_add_u32 s49, s49, s48
s_add_u32 m0, s75, 0
s_add_u32 s48, s49, 0
buffer_load_dwordx4 v205, s[64:67], s48 offen  lds
s_add_u32 m0, s75, 1024
s_add_u32 s48, s49, 1048576
buffer_load_dwordx4 v205, s[64:67], s48 offen  lds
s_add_u32 m0, s75, 2048
s_add_u32 s48, s49, 2097152
buffer_load_dwordx4 v205, s[64:67], s48 offen  lds
s_lshl_b32 s48, s28, 12
s_add_u32 m0, s48, 73728
s_nop 0
buffer_load_dwordx4 v4, s[68:71], s48 offen offset:0  lds
buffer_load_dwordx4 v4, s[68:71], s48 offen offset:1024  lds
buffer_load_dwordx4 v4, s[68:71], s48 offen offset:2048  lds
buffer_load_dwordx4 v4, s[68:71], s48 offen offset:3072  lds
buffer_load_dwordx4 v[16:19], v204, s[60:63], s72 offen nt
buffer_load_dwordx4 v[20:23], v204, s[60:63], s73 offen nt
buffer_load_dwordx4 v[24:27], v204, s[60:63], s74 offen nt
s_add_u32 s8, s46, 28377088
s_addc_u32 s9, s47, 0
s_and_b32 s9, s9, 0xffff
s_mov_b32 s10, 5308416
s_mov_b32 s11, 0x00020000
s_add_u32 s12, s46, 33685504
s_addc_u32 s13, s47, 0
s_and_b32 s13, s13, 0xffff
s_mov_b32 s14, 5308416
s_mov_b32 s15, 0x00020000
s_add_u32 s16, s46, 38993920
s_addc_u32 s17, s47, 0
s_and_b32 s17, s17, 0xffff
s_mov_b32 s18, 5308416
s_mov_b32 s19, 0x00020000
s_add_u32 s20, s46, 7143424
s_addc_u32 s21, s47, 0
s_and_b32 s21, s21, 0xffff
s_mov_b32 s22, 2359296
s_mov_b32 s23, 0x00020000
s_add_u32 s24, s46, 9502720
s_addc_u32 s25, s47, 0
s_and_b32 s25, s25, 0xffff
s_mov_b32 s26, 18874368
s_mov_b32 s27, 0x00020000
s_add_u32 s52, s46, 44302336
s_addc_u32 s53, s47, 0
s_and_b32 s53, s53, 0xffff
s_mov_b32 s54, 24576
s_mov_b32 s55, 0x00020000
s_lshl_b32 s48, s30, 2
s_add_u32 s48, s48, s28
s_mul_i32 s31, s48, 165888
s_mov_b32 s35, s31
s_add_u32 s56, s44, 0
s_addc_u32 s57, s45, 0
s_and_b32 s57, s57, 0xffff
s_mov_b32 s58, 5308416
s_mov_b32 s59, 0x00020000
v_lshrrev_b32 v12, 3, v1
v_mul_u32_u24 v12, 1152, v12
v_and_b32 v13, 7, v1
v_lshl_add_u32 v218, v13, 4, v12
s_lshl_b32 s83, s28, 13
s_add_u32 s83, s83, 102912
s_mul_i32 s48, s29, 3
s_add_u32 s48, s48, s28
s_add_u32 s48, s48, -1
s_cmp_eq_u32 s28, 0
s_cselect_b32 s48, 200, s48
s_mul_i32 s49, s48, 3641
s_lshr_b32 s49, s49, 16
s_mul_i32 s50, s49, 18
s_sub_u32 s50, s48, s50
s_mul_i32 s50, s50, 36864
s_lshl_b32 s49, s49, 7
s_add_u32 s50, s50, s49
s_mul_i32 s49, s30, 663552
s_add_u32 s42, s50, s49
s_mul_i32 s49, s30, 648
s_add_u32 s49, s49, s48
s_lshl_b32 s84, s49, 10
s_cmp_lt_u32 s48, 162
s_cselect_b32 s42, s42, 0x70000000
s_cselect_b32 s84, s84, 0x70000000
s_mul_i32 s48, s29, 3
s_add_u32 s48, s48, s28
s_add_u32 s48, s48, 95
s_cmp_eq_u32 s28, 0
s_cselect_b32 s48, 200, s48
s_mul_i32 s49, s48, 3641
s_lshr_b32 s49, s49, 16
s_mul_i32 s50, s49, 18
s_sub_u32 s50, s48, s50
s_mul_i32 s50, s50, 36864
s_lshl_b32 s49, s49, 7
s_add_u32 s50, s50, s49
s_mul_i32 s49, s30, 663552
s_add_u32 s43, s50, s49
s_mul_i32 s49, s30, 648
s_add_u32 s49, s49, s48
s_lshl_b32 s85, s49, 10
s_cmp_lt_u32 s48, 162
s_cselect_b32 s43, s43, 0x70000000
s_cselect_b32 s85, s85, 0x70000000
v_lshrrev_b32 v12, 4, v1
v_and_b32 v13, 15, v1
v_lshrrev_b32 v14, 2, v13
v_lshl_add_u32 v14, v12, 2, v14
v_lshlrev_b32 v14, 7, v14
v_and_b32 v15, 3, v13
v_lshl_add_u32 v14, v15, 3, v14
v_add_u32 v219, s83, v14
s_add_u32 m0, s83, 0
s_add_u32 s49, s42, 0
buffer_load_dwordx4 v218, s[56:59], s49 offen nt lds
s_add_u32 m0, s83, 1024
s_add_u32 s49, s42, 9216
buffer_load_dwordx4 v218, s[56:59], s49 offen nt lds
s_add_u32 m0, s83, 2048
s_add_u32 s49, s42, 18432
buffer_load_dwordx4 v218, s[56:59], s49 offen nt lds
s_add_u32 m0, s83, 3072
s_add_u32 s49, s42, 27648
buffer_load_dwordx4 v218, s[56:59], s49 offen nt lds
s_add_u32 m0, s83, 4096
s_add_u32 s49, s43, 0
buffer_load_dwordx4 v218, s[56:59], s49 offen nt lds
s_add_u32 m0, s83, 5120
s_add_u32 s49, s43, 9216
buffer_load_dwordx4 v218, s[56:59], s49 offen nt lds
s_add_u32 m0, s83, 6144
s_add_u32 s49, s43, 18432
buffer_load_dwordx4 v218, s[56:59], s49 offen nt lds
s_add_u32 m0, s83, 7168
s_add_u32 s49, s43, 27648
buffer_load_dwordx4 v218, s[56:59], s49 offen nt lds
v_lshrrev_b32 v12, 4, v1
v_and_b32 v13, 15, v1
v_bfe_u32 v14, v13, 1, 1
v_lshlrev_b32 v14, 3, v14
v_lshl_add_u32 v14, v12, 4, v14
v_lshrrev_b32 v15, 2, v13
v_add_u32 v14, v14, v15
v_lshlrev_b32 v14, 4, v14
v_and_b32 v15, 1, v13
v_lshl_add_u32 v14, v15, 3, v14
v_add_u32 v206, s75, v14
s_lshl_b32 s48, s28, 8
s_add_u32 s48, s48, 73728
v_lshlrev_b32 v207, 5, v3
v_add_u32 v207, s48, v207
v_lshrrev_b32 v12, 2, v3
v_lshlrev_b32 v12, 12, v12
v_and_b32 v13, 3, v3
v_lshl_add_u32 v12, v13, 8, v12
v_lshl_add_u32 v208, v2, 4, v12
v_lshlrev_b32 v210, 3, v2
v_add_u32 v210, 102400, v210
s_lshl_b32 s48, s28, 6
v_add_u32 v209, s48, v210
s_mul_i32 s49, s29, 73728
s_lshr_b32 s48, s30, 1
s_lshl_b32 s48, s48, 10
s_add_u32 s49, s49, s48
s_and_b32 s48, s30, 1
s_lshl_b32 s48, s48, 7
s_add_u32 s76, s49, s48
s_add_u32 s48, s28, 0
s_mul_i32 s77, s48, 8192
s_add_u32 s77, s77, s76
s_cmp_lt_u32 s48, 9
s_cselect_b32 s77, s77, 0x70000000
s_add_u32 s48, s28, 4
s_mul_i32 s78, s48, 8192
s_add_u32 s78, s78, s76
s_cmp_lt_u32 s48, 9
s_cselect_b32 s78, s78, 0x70000000
s_add_u32 s48, s28, 8
s_mul_i32 s79, s48, 8192
s_add_u32 s79, s79, s76
s_cmp_lt_u32 s48, 9
s_cselect_b32 s79, s79, 0x70000000
s_waitcnt vmcnt(8)
s_barrier
ds_read_b64_tr_b16 v[52:53], v206 offset:0
ds_read_b64_tr_b16 v[54:55], v206 offset:64
ds_read_b64_tr_b16 v[56:57], v206 offset:1024
ds_read_b64_tr_b16 v[58:59], v206 offset:1088
ds_read_b64_tr_b16 v[60:61], v206 offset:2048
ds_read_b64_tr_b16 v[62:63], v206 offset:2112
ds_read_b128 v[96:99], v207 offset:2304
ds_read_b128 v[100:103], v207 offset:2320
ds_read_b128 v[104:107], v207 offset:3328
ds_read_b128 v[108:111], v207 offset:3344
ds_read_b128 v[112:115], v207 offset:4352
ds_read_b128 v[116:119], v207 offset:4368
ds_read_b128 v[120:123], v207 offset:0
ds_read_b128 v[124:127], v207 offset:16
ds_read_b128 v[128:131], v207 offset:1024
ds_read_b128 v[132:135], v207 offset:1040
ds_read_b128 v[136:139], v207 offset:2048
ds_read_b128 v[140:143], v207 offset:2064
v_lshlrev_b32 v28, 16, v16
v_and_b32 v29, 0xffff0000, v16
v_lshlrev_b32 v30, 16, v17
v_and_b32 v31, 0xffff0000, v17
v_lshlrev_b32 v32, 16, v18
v_and_b32 v33, 0xffff0000, v18
v_lshlrev_b32 v34, 16, v19
v_and_b32 v35, 0xffff0000, v19
v_lshlrev_b32 v36, 16, v20
v_and_b32 v37, 0xffff0000, v20
v_lshlrev_b32 v38, 16, v21
v_and_b32 v39, 0xffff0000, v21
v_lshlrev_b32 v40, 16, v22
v_and_b32 v41, 0xffff0000, v22
v_lshlrev_b32 v42, 16, v23
v_and_b32 v43, 0xffff0000, v23
v_lshlrev_b32 v44, 16, v24
v_and_b32 v45, 0xffff0000, v24
v_lshlrev_b32 v46, 16, v25
v_and_b32 v47, 0xffff0000, v25
v_lshlrev_b32 v48, 16, v26
v_and_b32 v49, 0xffff0000, v26
v_lshlrev_b32 v50, 16, v27
v_and_b32 v51, 0xffff0000, v27
ds_read_b128 v[144:147], v207 offset:4608
ds_read_b128 v[148:151], v207 offset:4624
ds_read_b128 v[152:155], v207 offset:5632
ds_read_b128 v[156:159], v207 offset:5648
ds_read_b128 v[160:163], v207 offset:6656
ds_read_b128 v[164:167], v207 offset:6672
ds_read_b128 v[168:171], v207 offset:9216
ds_read_b128 v[172:175], v207 offset:9232
ds_read_b128 v[176:179], v207 offset:10240
ds_read_b128 v[180:183], v207 offset:10256
ds_read_b128 v[184:187], v207 offset:11264
ds_read_b128 v[188:191], v207 offset:11280
v_pk_add_f32 v[80:81], v[28:29], v[30:31]
v_pk_mul_f32 v[82:83], v[28:29], v[28:29]
v_pk_fma_f32 v[82:83], v[30:31], v[30:31], v[82:83]
v_pk_add_f32 v[80:81], v[80:81], v[32:33]
v_pk_fma_f32 v[82:83], v[32:33], v[32:33], v[82:83]
v_pk_add_f32 v[80:81], v[80:81], v[34:35]
v_pk_fma_f32 v[82:83], v[34:35], v[34:35], v[82:83]
v_pk_add_f32 v[80:81], v[80:81], v[36:37]
v_pk_fma_f32 v[82:83], v[36:37], v[36:37], v[82:83]
v_pk_add_f32 v[80:81], v[80:81], v[38:39]
v_pk_fma_f32 v[82:83], v[38:39], v[38:39], v[82:83]
v_pk_add_f32 v[80:81], v[80:81], v[40:41]
v_pk_fma_f32 v[82:83], v[40:41], v[40:41], v[82:83]
v_pk_add_f32 v[80:81], v[80:81], v[42:43]
v_pk_fma_f32 v[82:83], v[42:43], v[42:43], v[82:83]
v_pk_add_f32 v[80:81], v[80:81], v[44:45]
v_pk_fma_f32 v[82:83], v[44:45], v[44:45], v[82:83]
v_pk_add_f32 v[80:81], v[80:81], v[46:47]
v_pk_fma_f32 v[82:83], v[46:47], v[46:47], v[82:83]
v_pk_add_f32 v[80:81], v[80:81], v[48:49]
v_pk_fma_f32 v[82:83], v[48:49], v[48:49], v[82:83]
v_pk_add_f32 v[80:81], v[80:81], v[50:51]
v_pk_fma_f32 v[82:83], v[50:51], v[50:51], v[82:83]
v_add_f32 v212, v80, v81
v_add_f32 v213, v82, v83
ds_read_b128 v[64:67], v207 offset:6912
ds_read_b128 v[68:71], v207 offset:6928
ds_read_b128 v[72:75], v207 offset:7936
ds_read_b128 v[76:79], v207 offset:7952
ds_read_b128 v[16:19], v207 offset:8960
ds_read_b128 v[20:23], v207 offset:8976
s_nop 1
v_add_f32_dpp v212, v212, v212 row_ror:8 row_mask:0xf bank_mask:0xf
v_add_f32_dpp v213, v213, v213 row_ror:8 row_mask:0xf bank_mask:0xf
v_mov_b32 v80, v212
v_mov_b32 v81, v213
s_nop 0
v_permlane16_swap_b32 v80, v212
v_permlane16_swap_b32 v81, v213
s_nop 0
v_add_f32 v212, v212, v80
v_add_f32 v213, v213, v81
v_mov_b32 v80, v212
v_mov_b32 v81, v213
s_nop 0
v_permlane32_swap_b32 v80, v212
v_permlane32_swap_b32 v81, v213
s_nop 0
v_add_f32 v212, v212, v80
v_add_f32 v213, v213, v81
ds_write_b64 v209, v[212:213] offset:0
s_waitcnt lgkmcnt(0)
s_barrier
ds_read_b64 v[80:81], v210 offset:0
ds_read_b64 v[82:83], v210 offset:64
ds_read_b64 v[84:85], v210 offset:128
ds_read_b64 v[86:87], v210 offset:192
s_waitcnt lgkmcnt(0)
v_add_f32 v80, v80, v82
v_add_f32 v81, v81, v83
v_add_f32 v80, v80, v84
v_add_f32 v81, v81, v85
v_add_f32 v80, v80, v86
v_add_f32 v81, v81, v87
v_mul_f32 v216, 0x3ae38e39, v80
v_mul_f32 v81, 0x3ae38e39, v81
v_fma_f32 v81, -v216, v216, v81
v_max_f32 v81, 0, v81
v_add_f32 v81, 0x3727c5ac, v81
v_rsq_f32 v214, v81
s_nop 0
v_mul_f32 v216, v216, v214
v_lshlrev_b32 v80, 16, v52
v_and_b32 v81, 0xffff0000, v52
v_lshlrev_b32 v82, 16, v53
v_and_b32 v83, 0xffff0000, v53
v_lshlrev_b32 v84, 16, v54
v_and_b32 v85, 0xffff0000, v54
v_lshlrev_b32 v86, 16, v55
v_and_b32 v87, 0xffff0000, v55
v_pk_fma_f32 v[224:225], v[28:29], v[214:215], v[216:217] op_sel_hi:[1,0,0] neg_lo:[0,0,1] neg_hi:[0,0,1]
v_pk_fma_f32 v[224:225], v[224:225], v[96:97], v[120:121]
v_pk_mul_f32 v[224:225], v[224:225], v[80:81]
v_pk_fma_f32 v[224:225], v[224:225], v[144:145], v[28:29]
v_pk_fma_f32 v[226:227], v[30:31], v[214:215], v[216:217] op_sel_hi:[1,0,0] neg_lo:[0,0,1] neg_hi:[0,0,1]
v_pk_fma_f32 v[226:227], v[226:227], v[98:99], v[122:123]
v_pk_mul_f32 v[226:227], v[226:227], v[82:83]
v_pk_fma_f32 v[226:227], v[226:227], v[146:147], v[30:31]
v_pk_fma_f32 v[228:229], v[32:33], v[214:215], v[216:217] op_sel_hi:[1,0,0] neg_lo:[0,0,1] neg_hi:[0,0,1]
v_pk_fma_f32 v[228:229], v[228:229], v[100:101], v[124:125]
v_pk_mul_f32 v[228:229], v[228:229], v[84:85]
v_pk_fma_f32 v[228:229], v[228:229], v[148:149], v[32:33]
v_pk_fma_f32 v[230:231], v[34:35], v[214:215], v[216:217] op_sel_hi:[1,0,0] neg_lo:[0,0,1] neg_hi:[0,0,1]
v_pk_fma_f32 v[230:231], v[230:231], v[102:103], v[126:127]
v_pk_mul_f32 v[230:231], v[230:231], v[86:87]
v_pk_fma_f32 v[230:231], v[230:231], v[150:151], v[34:35]
v_lshlrev_b32 v80, 16, v56
v_and_b32 v81, 0xffff0000, v56
v_lshlrev_b32 v82, 16, v57
v_and_b32 v83, 0xffff0000, v57
v_lshlrev_b32 v84, 16, v58
v_and_b32 v85, 0xffff0000, v58
v_lshlrev_b32 v86, 16, v59
v_and_b32 v87, 0xffff0000, v59
v_pk_fma_f32 v[232:233], v[36:37], v[214:215], v[216:217] op_sel_hi:[1,0,0] neg_lo:[0,0,1] neg_hi:[0,0,1]
v_pk_fma_f32 v[232:233], v[232:233], v[104:105], v[128:129]
v_pk_mul_f32 v[232:233], v[232:233], v[80:81]
v_pk_fma_f32 v[232:233], v[232:233], v[152:153], v[36:37]
v_pk_fma_f32 v[234:235], v[38:39], v[214:215], v[216:217] op_sel_hi:[1,0,0] neg_lo:[0,0,1] neg_hi:[0,0,1]
v_pk_fma_f32 v[234:235], v[234:235], v[106:107], v[130:131]
v_pk_mul_f32 v[234:235], v[234:235], v[82:83]
v_pk_fma_f32 v[234:235], v[234:235], v[154:155], v[38:39]
v_pk_fma_f32 v[236:237], v[40:41], v[214:215], v[216:217] op_sel_hi:[1,0,0] neg_lo:[0,0,1] neg_hi:[0,0,1]
v_pk_fma_f32 v[236:237], v[236:237], v[108:109], v[132:133]
v_pk_mul_f32 v[236:237], v[236:237], v[84:85]
v_pk_fma_f32 v[236:237], v[236:237], v[156:157], v[40:41]
v_pk_fma_f32 v[238:239], v[42:43], v[214:215], v[216:217] op_sel_hi:[1,0,0] neg_lo:[0,0,1] neg_hi:[0,0,1]
v_pk_fma_f32 v[238:239], v[238:239], v[110:111], v[134:135]
v_pk_mul_f32 v[238:239], v[238:239], v[86:87]
v_pk_fma_f32 v[238:239], v[238:239], v[158:159], v[42:43]
v_lshlrev_b32 v80, 16, v60
v_and_b32 v81, 0xffff0000, v60
v_lshlrev_b32 v82, 16, v61
v_and_b32 v83, 0xffff0000, v61
v_lshlrev_b32 v84, 16, v62
v_and_b32 v85, 0xffff0000, v62
v_lshlrev_b32 v86, 16, v63
v_and_b32 v87, 0xffff0000, v63
v_pk_fma_f32 v[240:241], v[44:45], v[214:215], v[216:217] op_sel_hi:[1,0,0] neg_lo:[0,0,1] neg_hi:[0,0,1]
v_pk_fma_f32 v[240:241], v[240:241], v[112:113], v[136:137]
v_pk_mul_f32 v[240:241], v[240:241], v[80:81]
v_pk_fma_f32 v[240:241], v[240:241], v[160:161], v[44:45]
v_pk_fma_f32 v[242:243], v[46:47], v[214:215], v[216:217] op_sel_hi:[1,0,0] neg_lo:[0,0,1] neg_hi:[0,0,1]
v_pk_fma_f32 v[242:243], v[242:243], v[114:115], v[138:139]
v_pk_mul_f32 v[242:243], v[242:243], v[82:83]
v_pk_fma_f32 v[242:243], v[242:243], v[162:163], v[46:47]
v_pk_fma_f32 v[244:245], v[48:49], v[214:215], v[216:217] op_sel_hi:[1,0,0] neg_lo:[0,0,1] neg_hi:[0,0,1]
v_pk_fma_f32 v[244:245], v[244:245], v[116:117], v[140:141]
v_pk_mul_f32 v[244:245], v[244:245], v[84:85]
v_pk_fma_f32 v[244:245], v[244:245], v[164:165], v[48:49]
v_pk_fma_f32 v[246:247], v[50:51], v[214:215], v[216:217] op_sel_hi:[1,0,0] neg_lo:[0,0,1] neg_hi:[0,0,1]
v_pk_fma_f32 v[246:247], v[246:247], v[118:119], v[142:143]
v_pk_mul_f32 v[246:247], v[246:247], v[86:87]
v_pk_fma_f32 v[246:247], v[246:247], v[166:167], v[50:51]
v_cvt_pk_bf16_f32 v192, v224, v225
v_cvt_pk_bf16_f32 v193, v226, v227
v_cvt_pk_bf16_f32 v194, v228, v229
v_cvt_pk_bf16_f32 v195, v230, v231
v_cvt_pk_bf16_f32 v196, v232, v233
v_cvt_pk_bf16_f32 v197, v234, v235
v_cvt_pk_bf16_f32 v198, v236, v237
v_cvt_pk_bf16_f32 v199, v238, v239
v_cvt_pk_bf16_f32 v200, v240, v241
v_cvt_pk_bf16_f32 v201, v242, v243
v_cvt_pk_bf16_f32 v202, v244, v245
v_cvt_pk_bf16_f32 v203, v246, v247
v_lshlrev_b32 v224, 16, v192
v_and_b32 v225, 0xffff0000, v192
v_lshlrev_b32 v226, 16, v193
v_and_b32 v227, 0xffff0000, v193
v_lshlrev_b32 v228, 16, v194
v_and_b32 v229, 0xffff0000, v194
v_lshlrev_b32 v230, 16, v195
v_and_b32 v231, 0xffff0000, v195
v_lshlrev_b32 v232, 16, v196
v_and_b32 v233, 0xffff0000, v196
v_lshlrev_b32 v234, 16, v197
v_and_b32 v235, 0xffff0000, v197
v_lshlrev_b32 v236, 16, v198
v_and_b32 v237, 0xffff0000, v198
v_lshlrev_b32 v238, 16, v199
v_and_b32 v239, 0xffff0000, v199
v_lshlrev_b32 v240, 16, v200
v_and_b32 v241, 0xffff0000, v200
v_lshlrev_b32 v242, 16, v201
v_and_b32 v243, 0xffff0000, v201
v_lshlrev_b32 v244, 16, v202
v_and_b32 v245, 0xffff0000, v202
v_lshlrev_b32 v246, 16, v203
v_and_b32 v247, 0xffff0000, v203
v_pk_add_f32 v[80:81], v[224:225], v[226:227]
v_pk_mul_f32 v[82:83], v[224:225], v[224:225]
v_pk_fma_f32 v[82:83], v[226:227], v[226:227], v[82:83]
v_pk_add_f32 v[80:81], v[80:81], v[228:229]
v_pk_fma_f32 v[82:83], v[228:229], v[228:229], v[82:83]
v_pk_add_f32 v[80:81], v[80:81], v[230:231]
v_pk_fma_f32 v[82:83], v[230:231], v[230:231], v[82:83]
v_pk_add_f32 v[80:81], v[80:81], v[232:233]
v_pk_fma_f32 v[82:83], v[232:233], v[232:233], v[82:83]
v_pk_add_f32 v[80:81], v[80:81], v[234:235]
v_pk_fma_f32 v[82:83], v[234:235], v[234:235], v[82:83]
v_pk_add_f32 v[80:81], v[80:81], v[236:237]
v_pk_fma_f32 v[82:83], v[236:237], v[236:237], v[82:83]
v_pk_add_f32 v[80:81], v[80:81], v[238:239]
v_pk_fma_f32 v[82:83], v[238:239], v[238:239], v[82:83]
v_pk_add_f32 v[80:81], v[80:81], v[240:241]
v_pk_fma_f32 v[82:83], v[240:241], v[240:241], v[82:83]
v_pk_add_f32 v[80:81], v[80:81], v[242:243]
v_pk_fma_f32 v[82:83], v[242:243], v[242:243], v[82:83]
v_pk_add_f32 v[80:81], v[80:81], v[244:245]
v_pk_fma_f32 v[82:83], v[244:245], v[244:245], v[82:83]
v_pk_add_f32 v[80:81], v[80:81], v[246:247]
v_pk_fma_f32 v[82:83], v[246:247], v[246:247], v[82:83]
v_add_f32 v212, v80, v81
v_add_f32 v213, v82, v83
s_nop 1
v_add_f32_dpp v212, v212, v212 row_ror:8 row_mask:0xf bank_mask:0xf
v_add_f32_dpp v213, v213, v213 row_ror:8 row_mask:0xf bank_mask:0xf
v_mov_b32 v80, v212
v_mov_b32 v81, v213
s_nop 0
v_permlane16_swap_b32 v80, v212
v_permlane16_swap_b32 v81, v213
s_nop 0
v_add_f32 v212, v212, v80
v_add_f32 v213, v213, v81
v_mov_b32 v80, v212
v_mov_b32 v81, v213
s_nop 0
v_permlane32_swap_b32 v80, v212
v_permlane32_swap_b32 v81, v213
s_nop 0
v_add_f32 v212, v212, v80
v_add_f32 v213, v213, v81
ds_write_b64 v209, v[212:213] offset:256
s_waitcnt lgkmcnt(0)
s_barrier
ds_read_b64 v[80:81], v210 offset:256
ds_read_b64 v[82:83], v210 offset:320
ds_read_b64 v[84:85], v210 offset:384
ds_read_b64 v[86:87], v210 offset:448
s_waitcnt lgkmcnt(0)
v_add_f32 v80, v80, v82
v_add_f32 v81, v81, v83
v_add_f32 v80, v80, v84
v_add_f32 v81, v81, v85
v_add_f32 v80, v80, v86
v_add_f32 v81, v81, v87
v_mul_f32 v216, 0x3ae38e39, v80
v_mul_f32 v81, 0x3ae38e39, v81
v_fma_f32 v81, -v216, v216, v81
v_max_f32 v81, 0, v81
v_add_f32 v81, 0x3727c5ac, v81
v_rsq_f32 v214, v81
s_nop 0
v_mul_f32 v216, v216, v214
v_pk_fma_f32 v[224:225], v[224:225], v[214:215], v[216:217] op_sel_hi:[1,0,0] neg_lo:[0,0,1] neg_hi:[0,0,1]
v_pk_fma_f32 v[224:225], v[224:225], v[168:169], v[64:65]
v_pk_fma_f32 v[226:227], v[226:227], v[214:215], v[216:217] op_sel_hi:[1,0,0] neg_lo:[0,0,1] neg_hi:[0,0,1]
v_pk_fma_f32 v[226:227], v[226:227], v[170:171], v[66:67]
v_pk_fma_f32 v[228:229], v[228:229], v[214:215], v[216:217] op_sel_hi:[1,0,0] neg_lo:[0,0,1] neg_hi:[0,0,1]
v_pk_fma_f32 v[228:229], v[228:229], v[172:173], v[68:69]
v_pk_fma_f32 v[230:231], v[230:231], v[214:215], v[216:217] op_sel_hi:[1,0,0] neg_lo:[0,0,1] neg_hi:[0,0,1]
v_pk_fma_f32 v[230:231], v[230:231], v[174:175], v[70:71]
v_cvt_pk_bf16_f32 v28, v224, v225
v_cvt_pk_bf16_f32 v29, v226, v227
v_cvt_pk_bf16_f32 v30, v228, v229
v_cvt_pk_bf16_f32 v31, v230, v231
buffer_store_dwordx4 v[28:31], v208, s[20:23], s77 offen sc1
v_pk_fma_f32 v[232:233], v[232:233], v[214:215], v[216:217] op_sel_hi:[1,0,0] neg_lo:[0,0,1] neg_hi:[0,0,1]
v_pk_fma_f32 v[232:233], v[232:233], v[176:177], v[72:73]
v_pk_fma_f32 v[234:235], v[234:235], v[214:215], v[216:217] op_sel_hi:[1,0,0] neg_lo:[0,0,1] neg_hi:[0,0,1]
v_pk_fma_f32 v[234:235], v[234:235], v[178:179], v[74:75]
v_pk_fma_f32 v[236:237], v[236:237], v[214:215], v[216:217] op_sel_hi:[1,0,0] neg_lo:[0,0,1] neg_hi:[0,0,1]
v_pk_fma_f32 v[236:237], v[236:237], v[180:181], v[76:77]
v_pk_fma_f32 v[238:239], v[238:239], v[214:215], v[216:217] op_sel_hi:[1,0,0] neg_lo:[0,0,1] neg_hi:[0,0,1]
v_pk_fma_f32 v[238:239], v[238:239], v[182:183], v[78:79]
v_cvt_pk_bf16_f32 v32, v232, v233
v_cvt_pk_bf16_f32 v33, v234, v235
v_cvt_pk_bf16_f32 v34, v236, v237
v_cvt_pk_bf16_f32 v35, v238, v239
buffer_store_dwordx4 v[32:35], v208, s[20:23], s78 offen sc1
v_pk_fma_f32 v[240:241], v[240:241], v[214:215], v[216:217] op_sel_hi:[1,0,0] neg_lo:[0,0,1] neg_hi:[0,0,1]
v_pk_fma_f32 v[240:241], v[240:241], v[184:185], v[16:17]
v_pk_fma_f32 v[242:243], v[242:243], v[214:215], v[216:217] op_sel_hi:[1,0,0] neg_lo:[0,0,1] neg_hi:[0,0,1]
v_pk_fma_f32 v[242:243], v[242:243], v[186:187], v[18:19]
v_pk_fma_f32 v[244:245], v[244:245], v[214:215], v[216:217] op_sel_hi:[1,0,0] neg_lo:[0,0,1] neg_hi:[0,0,1]
v_pk_fma_f32 v[244:245], v[244:245], v[188:189], v[20:21]
v_pk_fma_f32 v[246:247], v[246:247], v[214:215], v[216:217] op_sel_hi:[1,0,0] neg_lo:[0,0,1] neg_hi:[0,0,1]
v_pk_fma_f32 v[246:247], v[246:247], v[190:191], v[22:23]
v_cvt_pk_bf16_f32 v36, v240, v241
v_cvt_pk_bf16_f32 v37, v242, v243
v_cvt_pk_bf16_f32 v38, v244, v245
v_cvt_pk_bf16_f32 v39, v246, v247
buffer_store_dwordx4 v[36:39], v208, s[20:23], s79 offen sc1
s_waitcnt vmcnt(0)
s_barrier
s_cmp_lg_u32 s28, 0
s_cbranch_scc1 ffn_kernel_w1_ok
s_cmp_lg_u32 s28, 0
s_cbranch_scc1 ffn_kernel_f1_set
s_lshl_b32 s49, s29, 7
s_lshl_b32 s48, s30, 2
s_add_u32 s49, s49, s48
s_add_u32 s49, s49, 0
v_mov_b32 v14, 0
v_mov_b32 v15, 1
s_mov_b64 s[50:51], exec
s_mov_b64 exec, 1
buffer_store_dword v15, v14, s[52:55], s49 offen sc1
s_mov_b64 exec, s[50:51]
ffn_kernel_f1_set:
s_cmp_lg_u32 s28, 0
s_cbranch_scc1 ffn_kernel_w1_ok
s_mov_b32 s48, 20000
s_lshl_b32 s49, s29, 7
v_lshlrev_b32 v12, 2, v1
s_add_u32 s49, s49, 0
v_mov_b32 v13, 0x7f000000
v_cmp_gt_u32 vcc, 8, v1
s_nop 1
v_cndmask_b32 v12, v13, v12, vcc
s_mov_b32 s50, 0xff
s_mov_b32 s51, 0
ffn_kernel_w1_poll:
buffer_load_dword v13, v12, s[52:55], s49 offen sc1
s_waitcnt vmcnt(0)
v_cmp_eq_u32 vcc, 1, v13
s_nop 3
s_cmp_eq_u64 vcc, s[50:51]
s_cbranch_scc1 ffn_kernel_w1_ok
s_sub_u32 s48, s48, 1
s_cmp_eq_u32 s48, 0
s_cbranch_scc1 ffn_kernel_w1_ok
s_sleep 2
s_branch ffn_kernel_w1_poll
ffn_kernel_w1_ok:
buffer_load_dwordx4 v[96:99], v4, s[8:11], s31 offen
buffer_load_dwordx4 v[100:103], v4, s[12:15], s31 offen
s_add_u32 s31, s31, 1024
buffer_load_dwordx4 v[104:107], v4, s[8:11], s31 offen
buffer_load_dwordx4 v[108:111], v4, s[12:15], s31 offen
s_add_u32 s31, s31, 1024
buffer_load_dwordx4 v[112:115], v4, s[8:11], s31 offen
buffer_load_dwordx4 v[116:119], v4, s[12:15], s31 offen
s_add_u32 s31, s31, 1024
buffer_load_dwordx4 v[120:123], v4, s[8:11], s31 offen
buffer_load_dwordx4 v[124:127], v4, s[12:15], s31 offen
s_add_u32 s31, s31, 1024
buffer_load_dwordx4 v[128:131], v4, s[8:11], s31 offen
buffer_load_dwordx4 v[132:135], v4, s[12:15], s31 offen
s_add_u32 s31, s31, 1024
buffer_load_dwordx4 v[136:139], v4, s[8:11], s31 offen
buffer_load_dwordx4 v[140:143], v4, s[12:15], s31 offen
s_add_u32 s31, s31, 1024
buffer_load_dwordx4 v[144:147], v4, s[8:11], s31 offen
buffer_load_dwordx4 v[148:151], v4, s[12:15], s31 offen
s_add_u32 s31, s31, 1024
buffer_load_dwordx4 v[152:155], v4, s[8:11], s31 offen
buffer_load_dwordx4 v[156:159], v4, s[12:15], s31 offen
s_add_u32 s31, s31, 1024
buffer_load_dwordx4 v[160:163], v4, s[8:11], s31 offen
buffer_load_dwordx4 v[164:167], v4, s[12:15], s31 offen
s_add_u32 s31, s31, 1024
buffer_load_dwordx4 v[168:171], v4, s[8:11], s31 offen
buffer_load_dwordx4 v[172:175], v4, s[12:15], s31 offen
s_add_u32 s31, s31, 1024
buffer_load_dwordx4 v[176:179], v4, s[8:11], s31 offen
buffer_load_dwordx4 v[180:183], v4, s[12:15], s31 offen
s_add_u32 s31, s31, 1024
s_barrier
s_lshl_b32 s49, s28, 10
s_add_u32 s34, s49, 0
s_mul_i32 s38, s29, 73728
s_add_u32 s38, s38, s49
s_add_u32 m0, s34, 0
s_nop 0
buffer_load_dwordx4 v4, s[20:23], s38 offen sc1 lds
s_add_u32 m0, s34, 4096
s_add_u32 s38, s38, 4096
buffer_load_dwordx4 v4, s[20:23], s38 offen sc1 lds
s_add_u32 m0, s34, 8192
s_add_u32 s38, s38, 4096
buffer_load_dwordx4 v4, s[20:23], s38 offen sc1 lds
s_add_u32 m0, s34, 12288
s_add_u32 s38, s38, 4096
buffer_load_dwordx4 v4, s[20:23], s38 offen sc1 lds
s_add_u32 m0, s34, 16384
s_add_u32 s38, s38, 4096
buffer_load_dwordx4 v4, s[20:23], s38 offen sc1 lds
s_add_u32 m0, s34, 20480
s_add_u32 s38, s38, 4096
buffer_load_dwordx4 v4, s[20:23], s38 offen sc1 lds
s_add_u32 m0, s34, 24576
s_add_u32 s38, s38, 4096
buffer_load_dwordx4 v4, s[20:23], s38 offen sc1 lds
s_add_u32 m0, s34, 28672
s_add_u32 s38, s38, 4096
buffer_load_dwordx4 v4, s[20:23], s38 offen sc1 lds
s_lshl_b32 s48, s29, 6
s_add_u32 s48, s48, s30
s_mul_i32 s36, s48, 9216
s_lshl_b32 s48, s28, 8
s_add_u32 s36, s36, s48
s_add_u32 s40, s36, 294912
s_mov_b32 s39, 0xbfb8aa3b
v_add_u32 v6, 0, v4
v_add_u32 v7, 0x10000, v6
s_and_b32 s48, s28, 1
s_lshl_b32 s48, s48, 3
s_lshr_b32 s49, s28, 1
s_lshl_b32 s49, s49, 12
s_add_u32 s48, s48, s49
v_add_u32 v5, s48, v6
v_and_b32 v12, 15, v1
v_lshrrev_b32 v13, 4, v1
v_lshrrev_b32 v15, 3, v12
v_and_b32 v16, 1, v13
v_lshl_add_u32 v15, v16, 1, v15
v_lshrrev_b32 v14, 1, v13
v_lshlrev_b32 v14, 7, v14
v_and_b32 v16, 7, v12
v_lshl_add_u32 v14, v16, 4, v14
v_mul_u32_u24 v16, 73728, v15
v_add_u32 v16, v16, v14
s_lshl_b32 s48, s28, 8
s_add_u32 s48, s48, 73728
v_add_u32 v14, s48, v14
v_mov_b32 v17, 0x7f000000
v_lshlrev_b32 v18, 4, v0
v_add_u32 v18, 82944, v18
s_sub_u32 s48, s30, 0
v_cmp_eq_u32 vcc, s48, v15
s_nop 1
v_cndmask_b32 v8, v16, v17, vcc
v_cndmask_b32 v10, v18, v14, vcc
s_sub_u32 s48, s30, 4
v_cmp_eq_u32 vcc, s48, v15
s_nop 1
v_cndmask_b32 v9, v16, v17, vcc
v_cndmask_b32 v11, v18, v14, vcc
s_lshl_b32 s32, s30, 7
s_add_u32 s32, s32, 8192
s_add_u32 s48, s32, 44302336
s_add_u32 s56, s46, s48
s_addc_u32 s57, s47, 0
s_mov_b32 s58, 0
s_waitcnt vmcnt(7)
s_barrier
ds_read_b128 a[0:3], v6 offset:0
ds_read_b128 a[4:7], v6 offset:1024
ds_read_b128 a[8:11], v6 offset:2048
ds_read_b128 a[12:15], v6 offset:3072
s_waitcnt lgkmcnt(0)
s_waitcnt vmcnt(5)
s_barrier
v_mfma_f32_16x16x32_bf16 v[16:19], v[96:99], a[0:3], 0
ds_read_b128 a[16:19], v6 offset:4096
ds_read_b128 a[20:23], v6 offset:5120
v_mfma_f32_16x16x32_bf16 v[20:23], v[96:99], a[4:7], 0
buffer_load_dwordx4 v[184:187], v4, s[8:11], s31 offen
v_mfma_f32_16x16x32_bf16 v[24:27], v[96:99], a[8:11], 0
ds_read_b128 a[24:27], v6 offset:6144
ds_read_b128 a[28:31], v6 offset:7168
v_mfma_f32_16x16x32_bf16 v[28:31], v[96:99], a[12:15], 0
s_add_u32 m0, s34, 32768
s_add_u32 s38, s38, 4096
buffer_load_dwordx4 v4, s[20:23], s38 offen sc1 lds
v_mfma_f32_16x16x32_bf16 v[32:35], v[100:103], a[0:3], 0
v_mfma_f32_16x16x32_bf16 v[36:39], v[100:103], a[4:7], 0
buffer_load_dwordx4 v[188:191], v4, s[12:15], s31 offen
s_add_u32 s31, s31, 1024
v_mfma_f32_16x16x32_bf16 v[40:43], v[100:103], a[8:11], 0
v_mfma_f32_16x16x32_bf16 v[44:47], v[100:103], a[12:15], 0
s_waitcnt lgkmcnt(0)
s_waitcnt vmcnt(8)
v_mfma_f32_16x16x32_bf16 v[16:19], v[104:107], a[16:19], v[16:19]
ds_read_b128 a[32:35], v6 offset:8192
ds_read_b128 a[36:39], v6 offset:9216
v_mfma_f32_16x16x32_bf16 v[20:23], v[104:107], a[20:23], v[20:23]
buffer_load_dwordx4 v[96:99], v4, s[8:11], s31 offen
v_mfma_f32_16x16x32_bf16 v[24:27], v[104:107], a[24:27], v[24:27]
ds_read_b128 a[40:43], v6 offset:10240
ds_read_b128 a[44:47], v6 offset:11264
v_mfma_f32_16x16x32_bf16 v[28:31], v[104:107], a[28:31], v[28:31]
s_add_u32 m0, s34, 36864
s_add_u32 s38, s38, 4096
buffer_load_dwordx4 v4, s[20:23], s38 offen sc1 lds
v_mfma_f32_16x16x32_bf16 v[32:35], v[108:111], a[16:19], v[32:35]
v_mfma_f32_16x16x32_bf16 v[36:39], v[108:111], a[20:23], v[36:39]
buffer_load_dwordx4 v[100:103], v4, s[12:15], s31 offen
s_add_u32 s31, s31, 1024
v_mfma_f32_16x16x32_bf16 v[40:43], v[108:111], a[24:27], v[40:43]
v_mfma_f32_16x16x32_bf16 v[44:47], v[108:111], a[28:31], v[44:47]
s_waitcnt lgkmcnt(0)
s_waitcnt vmcnt(9)
s_barrier
v_mfma_f32_16x16x32_bf16 v[16:19], v[112:115], a[32:35], v[16:19]
ds_read_b128 a[48:51], v6 offset:12288
ds_read_b128 a[52:55], v6 offset:13312
v_mfma_f32_16x16x32_bf16 v[20:23], v[112:115], a[36:39], v[20:23]
buffer_load_dwordx4 v[104:107], v4, s[8:11], s31 offen
v_mfma_f32_16x16x32_bf16 v[24:27], v[112:115], a[40:43], v[24:27]
ds_read_b128 a[56:59], v6 offset:14336
ds_read_b128 a[60:63], v6 offset:15360
v_mfma_f32_16x16x32_bf16 v[28:31], v[112:115], a[44:47], v[28:31]
s_add_u32 m0, s34, 40960
s_add_u32 s38, s38, 4096
buffer_load_dwordx4 v4, s[20:23], s38 offen sc1 lds
v_mfma_f32_16x16x32_bf16 v[32:35], v[116:119], a[32:35], v[32:35]
v_mfma_f32_16x16x32_bf16 v[36:39], v[116:119], a[36:39], v[36:39]
buffer_load_dwordx4 v[108:111], v4, s[12:15], s31 offen
s_add_u32 s31, s31, 1024
v_mfma_f32_16x16x32_bf16 v[40:43], v[116:119], a[40:43], v[40:43]
v_mfma_f32_16x16x32_bf16 v[44:47], v[116:119], a[44:47], v[44:47]
s_waitcnt lgkmcnt(0)
s_waitcnt vmcnt(12)
v_mfma_f32_16x16x32_bf16 v[16:19], v[120:123], a[48:51], v[16:19]
ds_read_b128 a[64:67], v6 offset:16384
ds_read_b128 a[68:71], v6 offset:17408
v_mfma_f32_16x16x32_bf16 v[20:23], v[120:123], a[52:55], v[20:23]
buffer_load_dwordx4 v[112:115], v4, s[8:11], s31 offen
v_mfma_f32_16x16x32_bf16 v[24:27], v[120:123], a[56:59], v[24:27]
ds_read_b128 a[72:75], v6 offset:18432
ds_read_b128 a[76:79], v6 offset:19456
v_mfma_f32_16x16x32_bf16 v[28:31], v[120:123], a[60:63], v[28:31]
s_add_u32 m0, s34, 45056
s_add_u32 s38, s38, 4096
buffer_load_dwordx4 v4, s[20:23], s38 offen sc1 lds
v_mfma_f32_16x16x32_bf16 v[32:35], v[124:127], a[48:51], v[32:35]
v_mfma_f32_16x16x32_bf16 v[36:39], v[124:127], a[52:55], v[36:39]
buffer_load_dwordx4 v[116:119], v4, s[12:15], s31 offen
s_add_u32 s31, s31, 1024
v_mfma_f32_16x16x32_bf16 v[40:43], v[124:127], a[56:59], v[40:43]
v_mfma_f32_16x16x32_bf16 v[44:47], v[124:127], a[60:63], v[44:47]
s_waitcnt lgkmcnt(0)
s_waitcnt vmcnt(13)
s_barrier
v_mfma_f32_16x16x32_bf16 v[16:19], v[128:131], a[64:67], v[16:19]
ds_read_b128 a[80:83], v6 offset:20480
ds_read_b128 a[84:87], v6 offset:21504
v_mfma_f32_16x16x32_bf16 v[20:23], v[128:131], a[68:71], v[20:23]
buffer_load_dwordx4 v[120:123], v4, s[8:11], s31 offen
v_mfma_f32_16x16x32_bf16 v[24:27], v[128:131], a[72:75], v[24:27]
ds_read_b128 a[88:91], v6 offset:22528
ds_read_b128 a[92:95], v6 offset:23552
v_mfma_f32_16x16x32_bf16 v[28:31], v[128:131], a[76:79], v[28:31]
s_add_u32 m0, s34, 49152
s_add_u32 s38, s38, 4096
buffer_load_dwordx4 v4, s[20:23], s38 offen sc1 lds
v_mfma_f32_16x16x32_bf16 v[32:35], v[132:135], a[64:67], v[32:35]
v_mfma_f32_16x16x32_bf16 v[36:39], v[132:135], a[68:71], v[36:39]
buffer_load_dwordx4 v[124:127], v4, s[12:15], s31 offen
s_add_u32 s31, s31, 1024
v_mfma_f32_16x16x32_bf16 v[40:43], v[132:135], a[72:75], v[40:43]
v_mfma_f32_16x16x32_bf16 v[44:47], v[132:135], a[76:79], v[44:47]
s_waitcnt lgkmcnt(0)
s_waitcnt vmcnt(16)
v_mfma_f32_16x16x32_bf16 v[16:19], v[136:139], a[80:83], v[16:19]
ds_read_b128 a[96:99], v6 offset:24576
ds_read_b128 a[100:103], v6 offset:25600
v_mfma_f32_16x16x32_bf16 v[20:23], v[136:139], a[84:87], v[20:23]
buffer_load_dwordx4 v[128:131], v4, s[8:11], s31 offen
v_mfma_f32_16x16x32_bf16 v[24:27], v[136:139], a[88:91], v[24:27]
ds_read_b128 a[104:107], v6 offset:26624
ds_read_b128 a[108:111], v6 offset:27648
v_mfma_f32_16x16x32_bf16 v[28:31], v[136:139], a[92:95], v[28:31]
s_add_u32 m0, s34, 53248
s_add_u32 s38, s38, 4096
buffer_load_dwordx4 v4, s[20:23], s38 offen sc1 lds
v_mfma_f32_16x16x32_bf16 v[32:35], v[140:143], a[80:83], v[32:35]
v_mfma_f32_16x16x32_bf16 v[36:39], v[140:143], a[84:87], v[36:39]
buffer_load_dwordx4 v[132:135], v4, s[12:15], s31 offen
s_add_u32 s31, s31, 1024
v_mfma_f32_16x16x32_bf16 v[40:43], v[140:143], a[88:91], v[40:43]
v_mfma_f32_16x16x32_bf16 v[44:47], v[140:143], a[92:95], v[44:47]
s_waitcnt lgkmcnt(0)
s_waitcnt vmcnt(16)
s_barrier
v_mfma_f32_16x16x32_bf16 v[16:19], v[144:147], a[96:99], v[16:19]
ds_read_b128 a[112:115], v6 offset:28672
ds_read_b128 a[116:119], v6 offset:29696
v_mfma_f32_16x16x32_bf16 v[20:23], v[144:147], a[100:103], v[20:23]
buffer_load_dwordx4 v[136:139], v4, s[8:11], s31 offen
v_mfma_f32_16x16x32_bf16 v[24:27], v[144:147], a[104:107], v[24:27]
ds_read_b128 a[120:123], v6 offset:30720
ds_read_b128 a[124:127], v6 offset:31744
v_mfma_f32_16x16x32_bf16 v[28:31], v[144:147], a[108:111], v[28:31]
s_add_u32 m0, s34, 57344
s_add_u32 s38, s38, 4096
buffer_load_dwordx4 v4, s[20:23], s38 offen sc1 lds
v_mfma_f32_16x16x32_bf16 v[32:35], v[148:151], a[96:99], v[32:35]
v_mfma_f32_16x16x32_bf16 v[36:39], v[148:151], a[100:103], v[36:39]
buffer_load_dwordx4 v[140:143], v4, s[12:15], s31 offen
s_add_u32 s31, s31, 1024
v_mfma_f32_16x16x32_bf16 v[40:43], v[148:151], a[104:107], v[40:43]
v_mfma_f32_16x16x32_bf16 v[44:47], v[148:151], a[108:111], v[44:47]
s_waitcnt lgkmcnt(0)
s_waitcnt vmcnt(19)
v_mfma_f32_16x16x32_bf16 v[16:19], v[152:155], a[112:115], v[16:19]
ds_read_b128 a[128:131], v6 offset:32768
ds_read_b128 a[132:135], v6 offset:33792
v_mfma_f32_16x16x32_bf16 v[20:23], v[152:155], a[116:119], v[20:23]
buffer_load_dwordx4 v[144:147], v4, s[8:11], s31 offen
v_mfma_f32_16x16x32_bf16 v[24:27], v[152:155], a[120:123], v[24:27]
ds_read_b128 a[136:139], v6 offset:34816
ds_read_b128 a[140:143], v6 offset:35840
v_mfma_f32_16x16x32_bf16 v[28:31], v[152:155], a[124:127], v[28:31]
s_add_u32 m0, s34, 61440
s_add_u32 s38, s38, 4096
buffer_load_dwordx4 v4, s[20:23], s38 offen sc1 lds
v_mfma_f32_16x16x32_bf16 v[32:35], v[156:159], a[112:115], v[32:35]
v_mfma_f32_16x16x32_bf16 v[36:39], v[156:159], a[116:119], v[36:39]
buffer_load_dwordx4 v[148:151], v4, s[12:15], s31 offen
s_add_u32 s31, s31, 1024
v_mfma_f32_16x16x32_bf16 v[40:43], v[156:159], a[120:123], v[40:43]
v_mfma_f32_16x16x32_bf16 v[44:47], v[156:159], a[124:127], v[44:47]
s_waitcnt lgkmcnt(0)
s_waitcnt vmcnt(16)
s_barrier
v_mfma_f32_16x16x32_bf16 v[16:19], v[160:163], a[128:131], v[16:19]
ds_read_b128 a[144:147], v6 offset:36864
ds_read_b128 a[148:151], v6 offset:37888
v_mfma_f32_16x16x32_bf16 v[20:23], v[160:163], a[132:135], v[20:23]
buffer_load_dwordx4 v[152:155], v4, s[8:11], s31 offen
v_mfma_f32_16x16x32_bf16 v[24:27], v[160:163], a[136:139], v[24:27]
ds_read_b128 a[152:155], v6 offset:38912
ds_read_b128 a[156:159], v6 offset:39936
v_mfma_f32_16x16x32_bf16 v[28:31], v[160:163], a[140:143], v[28:31]
s_add_u32 m0, s34, 65536
s_add_u32 s38, s38, 4096
buffer_load_dwordx4 v4, s[20:23], s38 offen sc1 lds
v_mfma_f32_16x16x32_bf16 v[32:35], v[164:167], a[128:131], v[32:35]
v_mfma_f32_16x16x32_bf16 v[36:39], v[164:167], a[132:135], v[36:39]
buffer_load_dwordx4 v[156:159], v4, s[12:15], s31 offen
s_add_u32 s31, s31, 1024
v_mfma_f32_16x16x32_bf16 v[40:43], v[164:167], a[136:139], v[40:43]
v_mfma_f32_16x16x32_bf16 v[44:47], v[164:167], a[140:143], v[44:47]
s_waitcnt lgkmcnt(0)
s_waitcnt vmcnt(19)
v_mfma_f32_16x16x32_bf16 v[16:19], v[168:171], a[144:147], v[16:19]
ds_read_b128 a[160:163], v6 offset:40960
ds_read_b128 a[164:167], v6 offset:41984
v_mfma_f32_16x16x32_bf16 v[20:23], v[168:171], a[148:151], v[20:23]
buffer_load_dwordx4 v[160:163], v4, s[8:11], s31 offen
v_mfma_f32_16x16x32_bf16 v[24:27], v[168:171], a[152:155], v[24:27]
ds_read_b128 a[168:171], v6 offset:43008
ds_read_b128 a[172:175], v6 offset:44032
v_mfma_f32_16x16x32_bf16 v[28:31], v[168:171], a[156:159], v[28:31]
s_add_u32 m0, s34, 69632
s_add_u32 s38, s38, 4096
buffer_load_dwordx4 v4, s[20:23], s38 offen sc1 lds
v_mfma_f32_16x16x32_bf16 v[32:35], v[172:175], a[144:147], v[32:35]
v_mfma_f32_16x16x32_bf16 v[36:39], v[172:175], a[148:151], v[36:39]
buffer_load_dwordx4 v[164:167], v4, s[12:15], s31 offen
s_add_u32 s31, s31, 1024
v_mfma_f32_16x16x32_bf16 v[40:43], v[172:175], a[152:155], v[40:43]
v_mfma_f32_16x16x32_bf16 v[44:47], v[172:175], a[156:159], v[44:47]
s_waitcnt lgkmcnt(0)
s_waitcnt vmcnt(16)
s_barrier
v_mfma_f32_16x16x32_bf16 v[16:19], v[176:179], a[160:163], v[16:19]
ds_read_b128 a[176:179], v6 offset:45056
ds_read_b128 a[180:183], v6 offset:46080
v_mfma_f32_16x16x32_bf16 v[20:23], v[176:179], a[164:167], v[20:23]
buffer_load_dwordx4 v[168:171], v4, s[8:11], s31 offen
ds_read_b64_tr_b16 v[48:49], v219 offset:0
v_mfma_f32_16x16x32_bf16 v[24:27], v[176:179], a[168:171], v[24:27]
ds_read_b128 a[184:187], v6 offset:47104
ds_read_b128 a[188:191], v6 offset:48128
v_mfma_f32_16x16x32_bf16 v[28:31], v[176:179], a[172:175], v[28:31]
ds_read_b64_tr_b16 v[50:51], v219 offset:2048
ds_read_b64_tr_b16 v[52:53], v219 offset:32
v_mfma_f32_16x16x32_bf16 v[32:35], v[180:183], a[160:163], v[32:35]
ds_read_b64_tr_b16 v[54:55], v219 offset:2080
ds_read_b64_tr_b16 v[56:57], v219 offset:64
v_mfma_f32_16x16x32_bf16 v[36:39], v[180:183], a[164:167], v[36:39]
buffer_load_dwordx4 v[172:175], v4, s[12:15], s31 offen
s_add_u32 s31, s31, 1024
v_mfma_f32_16x16x32_bf16 v[40:43], v[180:183], a[168:171], v[40:43]
ds_read_b64_tr_b16 v[58:59], v219 offset:2112
ds_read_b64_tr_b16 v[60:61], v219 offset:96
v_mfma_f32_16x16x32_bf16 v[44:47], v[180:183], a[172:175], v[44:47]
ds_read_b64_tr_b16 v[62:63], v219 offset:2144
ds_read_b64_tr_b16 v[64:65], v219 offset:4096
s_waitcnt lgkmcnt(0)
s_waitcnt vmcnt(18)
v_mfma_f32_16x16x32_bf16 v[16:19], v[184:187], a[176:179], v[16:19]
ds_read_b128 a[192:195], v6 offset:49152
ds_read_b128 a[196:199], v6 offset:50176
v_mfma_f32_16x16x32_bf16 v[20:23], v[184:187], a[180:183], v[20:23]
buffer_load_dwordx4 v[176:179], v4, s[8:11], s31 offen
ds_read_b64_tr_b16 v[66:67], v219 offset:6144
v_mfma_f32_16x16x32_bf16 v[24:27], v[184:187], a[184:187], v[24:27]
ds_read_b128 a[200:203], v6 offset:51200
ds_read_b128 a[204:207], v6 offset:52224
v_mfma_f32_16x16x32_bf16 v[28:31], v[184:187], a[188:191], v[28:31]
ds_read_b64_tr_b16 v[68:69], v219 offset:4128
ds_read_b64_tr_b16 v[70:71], v219 offset:6176
v_mfma_f32_16x16x32_bf16 v[32:35], v[188:191], a[176:179], v[32:35]
ds_read_b64_tr_b16 v[72:73], v219 offset:4160
ds_read_b64_tr_b16 v[74:75], v219 offset:6208
v_mfma_f32_16x16x32_bf16 v[36:39], v[188:191], a[180:183], v[36:39]
buffer_load_dwordx4 v[180:183], v4, s[12:15], s31 offen
s_add_u32 s31, s31, 1024
v_mfma_f32_16x16x32_bf16 v[40:43], v[188:191], a[184:187], v[40:43]
ds_read_b64_tr_b16 v[76:77], v219 offset:4192
ds_read_b64_tr_b16 v[78:79], v219 offset:6240
v_mfma_f32_16x16x32_bf16 v[44:47], v[188:191], a[188:191], v[44:47]
s_waitcnt lgkmcnt(0)
s_waitcnt vmcnt(14)
s_barrier
v_mfma_f32_16x16x32_bf16 v[16:19], v[96:99], a[192:195], v[16:19]
ds_read_b128 a[208:211], v6 offset:53248
ds_read_b128 a[212:215], v6 offset:54272
v_mfma_f32_16x16x32_bf16 v[20:23], v[96:99], a[196:199], v[20:23]
buffer_load_dwordx4 v[184:187], v4, s[8:11], s31 offen
v_mfma_f32_16x16x32_bf16 v[24:27], v[96:99], a[200:203], v[24:27]
ds_read_b128 a[216:219], v6 offset:55296
ds_read_b128 a[220:223], v6 offset:56320
v_mfma_f32_16x16x32_bf16 v[28:31], v[96:99], a[204:207], v[28:31]
v_mfma_f32_16x16x32_bf16 v[32:35], v[100:103], a[192:195], v[32:35]
v_mfma_f32_16x16x32_bf16 v[36:39], v[100:103], a[196:199], v[36:39]
buffer_load_dwordx4 v[188:191], v4, s[12:15], s31 offen
s_add_u32 s31, s31, 1024
v_mfma_f32_16x16x32_bf16 v[40:43], v[100:103], a[200:203], v[40:43]
v_mfma_f32_16x16x32_bf16 v[44:47], v[100:103], a[204:207], v[44:47]
s_waitcnt lgkmcnt(0)
s_waitcnt vmcnt(16)
v_mfma_f32_16x16x32_bf16 v[16:19], v[104:107], a[208:211], v[16:19]
ds_read_b128 a[224:227], v6 offset:57344
ds_read_b128 a[228:231], v6 offset:58368
v_mfma_f32_16x16x32_bf16 v[20:23], v[104:107], a[212:215], v[20:23]
buffer_load_dwordx4 v[96:99], v4, s[8:11], s31 offen
s_add_u32 s48, s84, 0
v_mfma_f32_16x16x32_bf16 v[24:27], v[104:107], a[216:219], v[24:27]
ds_read_b128 a[232:235], v6 offset:59392
ds_read_b128 a[236:239], v6 offset:60416
v_mfma_f32_16x16x32_bf16 v[28:31], v[104:107], a[220:223], v[28:31]
buffer_store_dwordx4 v[48:51], v4, s[16:19], s48 offen sc1
s_add_u32 s48, s84, 165888
v_mfma_f32_16x16x32_bf16 v[32:35], v[108:111], a[208:211], v[32:35]
buffer_store_dwordx4 v[52:55], v4, s[16:19], s48 offen sc1
s_add_u32 s48, s84, 331776
v_mfma_f32_16x16x32_bf16 v[36:39], v[108:111], a[212:215], v[36:39]
buffer_load_dwordx4 v[100:103], v4, s[12:15], s31 offen
s_add_u32 s31, s31, 1024
v_mfma_f32_16x16x32_bf16 v[40:43], v[108:111], a[216:219], v[40:43]
buffer_store_dwordx4 v[56:59], v4, s[16:19], s48 offen sc1
s_add_u32 s48, s84, 497664
v_mfma_f32_16x16x32_bf16 v[44:47], v[108:111], a[220:223], v[44:47]
buffer_store_dwordx4 v[60:63], v4, s[16:19], s48 offen sc1
s_add_u32 s48, s85, 0
s_waitcnt lgkmcnt(0)
s_waitcnt vmcnt(16)
s_barrier
v_mfma_f32_16x16x32_bf16 v[16:19], v[112:115], a[224:227], v[16:19]
ds_read_b128 a[240:243], v6 offset:61440
ds_read_b128 a[244:247], v6 offset:62464
v_mfma_f32_16x16x32_bf16 v[20:23], v[112:115], a[228:231], v[20:23]
buffer_load_dwordx4 v[104:107], v4, s[8:11], s31 offen
buffer_store_dwordx4 v[64:67], v4, s[16:19], s48 offen sc1
v_mfma_f32_16x16x32_bf16 v[24:27], v[112:115], a[232:235], v[24:27]
ds_read_b128 a[248:251], v6 offset:63488
ds_read_b128 a[252:255], v6 offset:64512
v_mfma_f32_16x16x32_bf16 v[28:31], v[112:115], a[236:239], v[28:31]
s_add_u32 s48, s85, 165888
buffer_store_dwordx4 v[68:71], v4, s[16:19], s48 offen sc1
v_mfma_f32_16x16x32_bf16 v[32:35], v[116:119], a[224:227], v[32:35]
s_add_u32 s48, s85, 331776
buffer_store_dwordx4 v[72:75], v4, s[16:19], s48 offen sc1
v_mfma_f32_16x16x32_bf16 v[36:39], v[116:119], a[228:231], v[36:39]
buffer_load_dwordx4 v[108:111], v4, s[12:15], s31 offen
s_add_u32 s31, s31, 1024
v_mfma_f32_16x16x32_bf16 v[40:43], v[116:119], a[232:235], v[40:43]
s_add_u32 s48, s85, 497664
buffer_store_dwordx4 v[76:79], v4, s[16:19], s48 offen sc1
v_mfma_f32_16x16x32_bf16 v[44:47], v[116:119], a[236:239], v[44:47]
s_waitcnt lgkmcnt(0)
s_waitcnt vmcnt(22)
v_mfma_f32_16x16x32_bf16 v[16:19], v[120:123], a[240:243], v[16:19]
ds_read_b128 v[224:227], v7 offset:0
ds_read_b128 v[228:231], v7 offset:1024
v_mfma_f32_16x16x32_bf16 v[20:23], v[120:123], a[244:247], v[20:23]
buffer_load_dwordx4 v[112:115], v4, s[8:11], s31 offen
v_mfma_f32_16x16x32_bf16 v[24:27], v[120:123], a[248:251], v[24:27]
ds_read_b128 v[232:235], v7 offset:2048
ds_read_b128 v[236:239], v7 offset:3072
v_mfma_f32_16x16x32_bf16 v[28:31], v[120:123], a[252:255], v[28:31]
v_mfma_f32_16x16x32_bf16 v[32:35], v[124:127], a[240:243], v[32:35]
v_mfma_f32_16x16x32_bf16 v[36:39], v[124:127], a[244:247], v[36:39]
buffer_load_dwordx4 v[116:119], v4, s[12:15], s31 offen
s_add_u32 s31, s31, 1024
v_mfma_f32_16x16x32_bf16 v[40:43], v[124:127], a[248:251], v[40:43]
v_mfma_f32_16x16x32_bf16 v[44:47], v[124:127], a[252:255], v[44:47]
s_waitcnt lgkmcnt(0)
s_waitcnt vmcnt(21)
s_barrier
v_mfma_f32_16x16x32_bf16 v[16:19], v[128:131], v[224:227], v[16:19]
ds_read_b128 v[240:243], v7 offset:4096
ds_read_b128 v[244:247], v7 offset:5120
v_mfma_f32_16x16x32_bf16 v[20:23], v[128:131], v[228:231], v[20:23]
buffer_load_dwordx4 v[120:123], v4, s[8:11], s31 offen
v_mfma_f32_16x16x32_bf16 v[24:27], v[128:131], v[232:235], v[24:27]
ds_read_b128 v[248:251], v7 offset:6144
ds_read_b128 v[252:255], v7 offset:7168
v_mfma_f32_16x16x32_bf16 v[28:31], v[128:131], v[236:239], v[28:31]
v_mfma_f32_16x16x32_bf16 v[32:35], v[132:135], v[224:227], v[32:35]
v_mfma_f32_16x16x32_bf16 v[36:39], v[132:135], v[228:231], v[36:39]
buffer_load_dwordx4 v[124:127], v4, s[12:15], s31 offen
s_add_u32 s31, s31, 1024
v_mfma_f32_16x16x32_bf16 v[40:43], v[132:135], v[232:235], v[40:43]
v_mfma_f32_16x16x32_bf16 v[44:47], v[132:135], v[236:239], v[44:47]
s_waitcnt lgkmcnt(0)
s_waitcnt vmcnt(23)
v_mfma_f32_16x16x32_bf16 v[16:19], v[136:139], v[240:243], v[16:19]
v_mfma_f32_16x16x32_bf16 v[20:23], v[136:139], v[244:247], v[20:23]
buffer_load_dwordx4 v[128:131], v4, s[8:11], s31 offen
v_mfma_f32_16x16x32_bf16 v[24:27], v[136:139], v[248:251], v[24:27]
v_mfma_f32_16x16x32_bf16 v[28:31], v[136:139], v[252:255], v[28:31]
v_mfma_f32_16x16x32_bf16 v[32:35], v[140:143], v[240:243], v[32:35]
v_mfma_f32_16x16x32_bf16 v[36:39], v[140:143], v[244:247], v[36:39]
buffer_load_dwordx4 v[132:135], v4, s[12:15], s31 offen
s_add_u32 s31, s31, 1024
v_mfma_f32_16x16x32_bf16 v[40:43], v[140:143], v[248:251], v[40:43]
v_mfma_f32_16x16x32_bf16 v[44:47], v[140:143], v[252:255], v[44:47]
s_barrier
s_mov_b32 s37, 4
ffn_kernel_l1:
s_waitcnt vmcnt(20)
v_mfma_f32_16x16x32_bf16 v[48:51], v[144:147], a[0:3], 0
v_mfma_f32_16x16x32_bf16 v[52:55], v[144:147], a[4:7], 0
buffer_load_dwordx4 v[136:139], v4, s[8:11], s31 offen
v_mfma_f32_16x16x32_bf16 v[56:59], v[144:147], a[8:11], 0
v_mfma_f32_16x16x32_bf16 v[60:63], v[144:147], a[12:15], 0
v_mfma_f32_16x16x32_bf16 v[64:67], v[148:151], a[0:3], 0
v_mfma_f32_16x16x32_bf16 v[68:71], v[148:151], a[4:7], 0
buffer_load_dwordx4 v[140:143], v4, s[12:15], s31 offen
s_add_u32 s31, s31, 1024
v_mfma_f32_16x16x32_bf16 v[72:75], v[148:151], a[8:11], 0
v_mfma_f32_16x16x32_bf16 v[76:79], v[148:151], a[12:15], 0
s_waitcnt vmcnt(20)
v_mfma_f32_16x16x32_bf16 v[48:51], v[152:155], a[16:19], v[48:51]
v_mul_f32 v80, s39, v16
v_mul_f32 v81, s39, v17
v_mfma_f32_16x16x32_bf16 v[52:55], v[152:155], a[20:23], v[52:55]
buffer_load_dwordx4 v[144:147], v4, s[8:11], s31 offen
v_mfma_f32_16x16x32_bf16 v[56:59], v[152:155], a[24:27], v[56:59]
v_exp_f32 v80, v80
v_mfma_f32_16x16x32_bf16 v[60:63], v[152:155], a[28:31], v[60:63]
v_exp_f32 v81, v81
v_mfma_f32_16x16x32_bf16 v[64:67], v[156:159], a[16:19], v[64:67]
v_mul_f32 v82, v16, v32
v_mul_f32 v83, v17, v33
v_mfma_f32_16x16x32_bf16 v[68:71], v[156:159], a[20:23], v[68:71]
buffer_load_dwordx4 v[148:151], v4, s[12:15], s31 offen
s_add_u32 s31, s31, 1024
v_mfma_f32_16x16x32_bf16 v[72:75], v[156:159], a[24:27], v[72:75]
v_add_f32 v80, 1.0, v80
v_add_f32 v81, 1.0, v81
v_mfma_f32_16x16x32_bf16 v[76:79], v[156:159], a[28:31], v[76:79]
v_rcp_f32 v80, v80
s_waitcnt vmcnt(20)
v_mfma_f32_16x16x32_bf16 v[48:51], v[160:163], a[32:35], v[48:51]
v_rcp_f32 v81, v81
v_mfma_f32_16x16x32_bf16 v[52:55], v[160:163], a[36:39], v[52:55]
buffer_load_dwordx4 v[152:155], v4, s[8:11], s31 offen
v_mul_f32 v82, v82, v80
v_mfma_f32_16x16x32_bf16 v[56:59], v[160:163], a[40:43], v[56:59]
v_mul_f32 v83, v83, v81
v_cvt_pk_bf16_f32 v88, v82, v83
v_mfma_f32_16x16x32_bf16 v[60:63], v[160:163], a[44:47], v[60:63]
s_cmp_eq_u32 s37, 1
s_cbranch_scc0 ffn_kernel_p3
s_load_dword s58, s[56:57], 0
ffn_kernel_p3:
v_mfma_f32_16x16x32_bf16 v[64:67], v[164:167], a[32:35], v[64:67]
v_mul_f32 v84, s39, v18
v_mul_f32 v85, s39, v19
v_mfma_f32_16x16x32_bf16 v[68:71], v[164:167], a[36:39], v[68:71]
buffer_load_dwordx4 v[156:159], v4, s[12:15], s31 offen
s_add_u32 s31, s31, 1024
v_mfma_f32_16x16x32_bf16 v[72:75], v[164:167], a[40:43], v[72:75]
v_exp_f32 v84, v84
v_mfma_f32_16x16x32_bf16 v[76:79], v[164:167], a[44:47], v[76:79]
v_exp_f32 v85, v85
s_waitcnt vmcnt(20)
v_mfma_f32_16x16x32_bf16 v[48:51], v[168:171], a[48:51], v[48:51]
v_mul_f32 v86, v18, v34
v_mul_f32 v87, v19, v35
v_mfma_f32_16x16x32_bf16 v[52:55], v[168:171], a[52:55], v[52:55]
buffer_load_dwordx4 v[160:163], v4, s[8:11], s31 offen
v_add_f32 v84, 1.0, v84
v_mfma_f32_16x16x32_bf16 v[56:59], v[168:171], a[56:59], v[56:59]
v_add_f32 v85, 1.0, v85
v_mfma_f32_16x16x32_bf16 v[60:63], v[168:171], a[60:63], v[60:63]
v_rcp_f32 v84, v84
v_mfma_f32_16x16x32_bf16 v[64:67], v[172:175], a[48:51], v[64:67]
v_rcp_f32 v85, v85
v_mfma_f32_16x16x32_bf16 v[68:71], v[172:175], a[52:55], v[68:71]
buffer_load_dwordx4 v[164:167], v4, s[12:15], s31 offen
s_add_u32 s31, s31, 1024
v_mfma_f32_16x16x32_bf16 v[72:75], v[172:175], a[56:59], v[72:75]
v_mul_f32 v86, v86, v84
v_mul_f32 v87, v87, v85
v_mfma_f32_16x16x32_bf16 v[76:79], v[172:175], a[60:63], v[76:79]
v_cvt_pk_bf16_f32 v89, v86, v87
ds_write_b64 v5, v[88:89] offset:0
s_waitcnt vmcnt(20)
v_mfma_f32_16x16x32_bf16 v[48:51], v[176:179], a[64:67], v[48:51]
v_mul_f32 v80, s39, v20
v_mul_f32 v81, s39, v21
v_mfma_f32_16x16x32_bf16 v[52:55], v[176:179], a[68:71], v[52:55]
buffer_load_dwordx4 v[168:171], v4, s[8:11], s31 offen
v_mfma_f32_16x16x32_bf16 v[56:59], v[176:179], a[72:75], v[56:59]
v_exp_f32 v80, v80
v_mfma_f32_16x16x32_bf16 v[60:63], v[176:179], a[76:79], v[60:63]
v_exp_f32 v81, v81
v_mfma_f32_16x16x32_bf16 v[64:67], v[180:183], a[64:67], v[64:67]
v_mul_f32 v82, v20, v36
v_mul_f32 v83, v21, v37
v_mfma_f32_16x16x32_bf16 v[68:71], v[180:183], a[68:71], v[68:71]
buffer_load_dwordx4 v[172:175], v4, s[12:15], s31 offen
s_add_u32 s31, s31, 1024
v_mfma_f32_16x16x32_bf16 v[72:75], v[180:183], a[72:75], v[72:75]
v_add_f32 v80, 1.0, v80
v_add_f32 v81, 1.0, v81
v_mfma_f32_16x16x32_bf16 v[76:79], v[180:183], a[76:79], v[76:79]
v_rcp_f32 v80, v80
s_waitcnt vmcnt(20)
v_mfma_f32_16x16x32_bf16 v[48:51], v[184:187], a[80:83], v[48:51]
v_rcp_f32 v81, v81
v_mfma_f32_16x16x32_bf16 v[52:55], v[184:187], a[84:87], v[52:55]
buffer_load_dwordx4 v[176:179], v4, s[8:11], s31 offen
v_mul_f32 v82, v82, v80
v_mfma_f32_16x16x32_bf16 v[56:59], v[184:187], a[88:91], v[56:59]
v_mul_f32 v83, v83, v81
v_cvt_pk_bf16_f32 v90, v82, v83
v_mfma_f32_16x16x32_bf16 v[60:63], v[184:187], a[92:95], v[60:63]
v_mul_f32 v84, s39, v22
v_mul_f32 v85, s39, v23
v_mfma_f32_16x16x32_bf16 v[64:67], v[188:191], a[80:83], v[64:67]
v_exp_f32 v84, v84
v_mfma_f32_16x16x32_bf16 v[68:71], v[188:191], a[84:87], v[68:71]
buffer_load_dwordx4 v[180:183], v4, s[12:15], s31 offen
s_add_u32 s31, s31, 1024
v_mfma_f32_16x16x32_bf16 v[72:75], v[188:191], a[88:91], v[72:75]
v_exp_f32 v85, v85
v_mfma_f32_16x16x32_bf16 v[76:79], v[188:191], a[92:95], v[76:79]
v_mul_f32 v86, v22, v38
v_mul_f32 v87, v23, v39
s_waitcnt vmcnt(20)
v_mfma_f32_16x16x32_bf16 v[48:51], v[96:99], a[96:99], v[48:51]
v_add_f32 v84, 1.0, v84
v_add_f32 v85, 1.0, v85
v_mfma_f32_16x16x32_bf16 v[52:55], v[96:99], a[100:103], v[52:55]
buffer_load_dwordx4 v[184:187], v4, s[8:11], s31 offen
v_mfma_f32_16x16x32_bf16 v[56:59], v[96:99], a[104:107], v[56:59]
v_rcp_f32 v84, v84
v_mfma_f32_16x16x32_bf16 v[60:63], v[96:99], a[108:111], v[60:63]
v_rcp_f32 v85, v85
v_mfma_f32_16x16x32_bf16 v[64:67], v[100:103], a[96:99], v[64:67]
v_mul_f32 v86, v86, v84
v_mul_f32 v87, v87, v85
v_mfma_f32_16x16x32_bf16 v[68:71], v[100:103], a[100:103], v[68:71]
buffer_load_dwordx4 v[188:191], v4, s[12:15], s31 offen
s_add_u32 s31, s31, 1024
v_mfma_f32_16x16x32_bf16 v[72:75], v[100:103], a[104:107], v[72:75]
v_cvt_pk_bf16_f32 v91, v86, v87
ds_write_b64 v5, v[90:91] offset:1024
v_mfma_f32_16x16x32_bf16 v[76:79], v[100:103], a[108:111], v[76:79]
v_mul_f32 v80, s39, v24
v_mul_f32 v81, s39, v25
s_waitcnt vmcnt(20)
v_mfma_f32_16x16x32_bf16 v[48:51], v[104:107], a[112:115], v[48:51]
v_exp_f32 v80, v80
v_mfma_f32_16x16x32_bf16 v[52:55], v[104:107], a[116:119], v[52:55]
buffer_load_dwordx4 v[96:99], v4, s[8:11], s31 offen
v_mfma_f32_16x16x32_bf16 v[56:59], v[104:107], a[120:123], v[56:59]
v_exp_f32 v81, v81
v_mfma_f32_16x16x32_bf16 v[60:63], v[104:107], a[124:127], v[60:63]
v_mul_f32 v82, v24, v40
v_mul_f32 v83, v25, v41
v_mfma_f32_16x16x32_bf16 v[64:67], v[108:111], a[112:115], v[64:67]
v_add_f32 v80, 1.0, v80
v_add_f32 v81, 1.0, v81
v_mfma_f32_16x16x32_bf16 v[68:71], v[108:111], a[116:119], v[68:71]
buffer_load_dwordx4 v[100:103], v4, s[12:15], s31 offen
s_add_u32 s31, s31, 1024
v_mfma_f32_16x16x32_bf16 v[72:75], v[108:111], a[120:123], v[72:75]
v_rcp_f32 v80, v80
v_mfma_f32_16x16x32_bf16 v[76:79], v[108:111], a[124:127], v[76:79]
v_rcp_f32 v81, v81
s_waitcnt vmcnt(20)
v_mfma_f32_16x16x32_bf16 v[48:51], v[112:115], a[128:131], v[48:51]
v_mul_f32 v82, v82, v80
v_mul_f32 v83, v83, v81
v_mfma_f32_16x16x32_bf16 v[52:55], v[112:115], a[132:135], v[52:55]
buffer_load_dwordx4 v[104:107], v4, s[8:11], s31 offen
v_cvt_pk_bf16_f32 v92, v82, v83
v_mfma_f32_16x16x32_bf16 v[56:59], v[112:115], a[136:139], v[56:59]
v_mul_f32 v84, s39, v26
v_mul_f32 v85, s39, v27
v_mfma_f32_16x16x32_bf16 v[60:63], v[112:115], a[140:143], v[60:63]
v_exp_f32 v84, v84
v_mfma_f32_16x16x32_bf16 v[64:67], v[116:119], a[128:131], v[64:67]
v_exp_f32 v85, v85
v_mfma_f32_16x16x32_bf16 v[68:71], v[116:119], a[132:135], v[68:71]
buffer_load_dwordx4 v[108:111], v4, s[12:15], s31 offen
s_add_u32 s31, s31, 1024
v_mfma_f32_16x16x32_bf16 v[72:75], v[116:119], a[136:139], v[72:75]
v_mul_f32 v86, v26, v42
v_mul_f32 v87, v27, v43
v_mfma_f32_16x16x32_bf16 v[76:79], v[116:119], a[140:143], v[76:79]
v_add_f32 v84, 1.0, v84
v_add_f32 v85, 1.0, v85
s_waitcnt vmcnt(20)
v_mfma_f32_16x16x32_bf16 v[48:51], v[120:123], a[144:147], v[48:51]
v_rcp_f32 v84, v84
v_mfma_f32_16x16x32_bf16 v[52:55], v[120:123], a[148:151], v[52:55]
buffer_load_dwordx4 v[112:115], v4, s[8:11], s31 offen
v_mfma_f32_16x16x32_bf16 v[56:59], v[120:123], a[152:155], v[56:59]
v_rcp_f32 v85, v85
v_mfma_f32_16x16x32_bf16 v[60:63], v[120:123], a[156:159], v[60:63]
v_mul_f32 v86, v86, v84
v_mul_f32 v87, v87, v85
v_mfma_f32_16x16x32_bf16 v[64:67], v[124:127], a[144:147], v[64:67]
v_cvt_pk_bf16_f32 v93, v86, v87
ds_write_b64 v5, v[92:93] offset:2048
v_mfma_f32_16x16x32_bf16 v[68:71], v[124:127], a[148:151], v[68:71]
buffer_load_dwordx4 v[116:119], v4, s[12:15], s31 offen
s_add_u32 s31, s31, 1024
v_mfma_f32_16x16x32_bf16 v[72:75], v[124:127], a[152:155], v[72:75]
v_mul_f32 v80, s39, v28
v_mul_f32 v81, s39, v29
v_mfma_f32_16x16x32_bf16 v[76:79], v[124:127], a[156:159], v[76:79]
v_exp_f32 v80, v80
s_waitcnt vmcnt(20)
v_mfma_f32_16x16x32_bf16 v[48:51], v[128:131], a[160:163], v[48:51]
v_exp_f32 v81, v81
v_mfma_f32_16x16x32_bf16 v[52:55], v[128:131], a[164:167], v[52:55]
buffer_load_dwordx4 v[120:123], v4, s[8:11], s31 offen
v_mul_f32 v82, v28, v44
v_mfma_f32_16x16x32_bf16 v[56:59], v[128:131], a[168:171], v[56:59]
v_mul_f32 v83, v29, v45
v_add_f32 v80, 1.0, v80
v_mfma_f32_16x16x32_bf16 v[60:63], v[128:131], a[172:175], v[60:63]
v_add_f32 v81, 1.0, v81
v_mfma_f32_16x16x32_bf16 v[64:67], v[132:135], a[160:163], v[64:67]
v_rcp_f32 v80, v80
v_mfma_f32_16x16x32_bf16 v[68:71], v[132:135], a[164:167], v[68:71]
buffer_load_dwordx4 v[124:127], v4, s[12:15], s31 offen
s_add_u32 s31, s31, 1024
v_mfma_f32_16x16x32_bf16 v[72:75], v[132:135], a[168:171], v[72:75]
v_rcp_f32 v81, v81
v_mfma_f32_16x16x32_bf16 v[76:79], v[132:135], a[172:175], v[76:79]
v_mul_f32 v82, v82, v80
v_mul_f32 v83, v83, v81
s_waitcnt vmcnt(20)
v_mfma_f32_16x16x32_bf16 v[48:51], v[136:139], a[176:179], v[48:51]
v_cvt_pk_bf16_f32 v94, v82, v83
v_mul_f32 v84, s39, v30
v_mfma_f32_16x16x32_bf16 v[52:55], v[136:139], a[180:183], v[52:55]
buffer_load_dwordx4 v[128:131], v4, s[8:11], s31 offen
v_mul_f32 v85, s39, v31
v_mfma_f32_16x16x32_bf16 v[56:59], v[136:139], a[184:187], v[56:59]
v_exp_f32 v84, v84
v_mfma_f32_16x16x32_bf16 v[60:63], v[136:139], a[188:191], v[60:63]
v_exp_f32 v85, v85
v_mfma_f32_16x16x32_bf16 v[64:67], v[140:143], a[176:179], v[64:67]
v_mul_f32 v86, v30, v46
v_mul_f32 v87, v31, v47
v_mfma_f32_16x16x32_bf16 v[68:71], v[140:143], a[180:183], v[68:71]
buffer_load_dwordx4 v[132:135], v4, s[12:15], s31 offen
s_add_u32 s31, s31, 1024
v_mfma_f32_16x16x32_bf16 v[72:75], v[140:143], a[184:187], v[72:75]
v_add_f32 v84, 1.0, v84
v_add_f32 v85, 1.0, v85
v_mfma_f32_16x16x32_bf16 v[76:79], v[140:143], a[188:191], v[76:79]
v_rcp_f32 v84, v84
s_waitcnt vmcnt(20)
v_mfma_f32_16x16x32_bf16 v[48:51], v[144:147], a[192:195], v[48:51]
v_rcp_f32 v85, v85
v_mfma_f32_16x16x32_bf16 v[52:55], v[144:147], a[196:199], v[52:55]
buffer_load_dwordx4 v[136:139], v4, s[8:11], s31 offen
v_mul_f32 v86, v86, v84
v_mfma_f32_16x16x32_bf16 v[56:59], v[144:147], a[200:203], v[56:59]
v_mul_f32 v87, v87, v85
v_cvt_pk_bf16_f32 v95, v86, v87
v_mfma_f32_16x16x32_bf16 v[60:63], v[144:147], a[204:207], v[60:63]
ds_write_b64 v5, v[94:95] offset:3072
v_add_u32 v5, 0x2000, v5
v_mfma_f32_16x16x32_bf16 v[64:67], v[148:151], a[192:195], v[64:67]
v_mfma_f32_16x16x32_bf16 v[68:71], v[148:151], a[196:199], v[68:71]
buffer_load_dwordx4 v[140:143], v4, s[12:15], s31 offen
s_add_u32 s31, s31, 1024
v_mfma_f32_16x16x32_bf16 v[72:75], v[148:151], a[200:203], v[72:75]
v_mfma_f32_16x16x32_bf16 v[76:79], v[148:151], a[204:207], v[76:79]
s_waitcnt vmcnt(20)
v_mfma_f32_16x16x32_bf16 v[48:51], v[152:155], a[208:211], v[48:51]
v_mfma_f32_16x16x32_bf16 v[52:55], v[152:155], a[212:215], v[52:55]
buffer_load_dwordx4 v[144:147], v4, s[8:11], s31 offen
v_mfma_f32_16x16x32_bf16 v[56:59], v[152:155], a[216:219], v[56:59]
v_mfma_f32_16x16x32_bf16 v[60:63], v[152:155], a[220:223], v[60:63]
v_mfma_f32_16x16x32_bf16 v[64:67], v[156:159], a[208:211], v[64:67]
v_mfma_f32_16x16x32_bf16 v[68:71], v[156:159], a[212:215], v[68:71]
buffer_load_dwordx4 v[148:151], v4, s[12:15], s31 offen
s_add_u32 s31, s31, 1024
v_mfma_f32_16x16x32_bf16 v[72:75], v[156:159], a[216:219], v[72:75]
v_mfma_f32_16x16x32_bf16 v[76:79], v[156:159], a[220:223], v[76:79]
s_waitcnt vmcnt(20)
v_mfma_f32_16x16x32_bf16 v[48:51], v[160:163], a[224:227], v[48:51]
v_mfma_f32_16x16x32_bf16 v[52:55], v[160:163], a[228:231], v[52:55]
buffer_load_dwordx4 v[152:155], v4, s[8:11], s31 offen
v_mfma_f32_16x16x32_bf16 v[56:59], v[160:163], a[232:235], v[56:59]
v_mfma_f32_16x16x32_bf16 v[60:63], v[160:163], a[236:239], v[60:63]
v_mfma_f32_16x16x32_bf16 v[64:67], v[164:167], a[224:227], v[64:67]
v_mfma_f32_16x16x32_bf16 v[68:71], v[164:167], a[228:231], v[68:71]
buffer_load_dwordx4 v[156:159], v4, s[12:15], s31 offen
s_add_u32 s31, s31, 1024
v_mfma_f32_16x16x32_bf16 v[72:75], v[164:167], a[232:235], v[72:75]
v_mfma_f32_16x16x32_bf16 v[76:79], v[164:167], a[236:239], v[76:79]
s_waitcnt vmcnt(20)
v_mfma_f32_16x16x32_bf16 v[48:51], v[168:171], a[240:243], v[48:51]
v_mfma_f32_16x16x32_bf16 v[52:55], v[168:171], a[244:247], v[52:55]
buffer_load_dwordx4 v[160:163], v4, s[8:11], s31 offen
v_mfma_f32_16x16x32_bf16 v[56:59], v[168:171], a[248:251], v[56:59]
v_mfma_f32_16x16x32_bf16 v[60:63], v[168:171], a[252:255], v[60:63]
v_mfma_f32_16x16x32_bf16 v[64:67], v[172:175], a[240:243], v[64:67]
v_mfma_f32_16x16x32_bf16 v[68:71], v[172:175], a[244:247], v[68:71]
buffer_load_dwordx4 v[164:167], v4, s[12:15], s31 offen
s_add_u32 s31, s31, 1024
v_mfma_f32_16x16x32_bf16 v[72:75], v[172:175], a[248:251], v[72:75]
v_mfma_f32_16x16x32_bf16 v[76:79], v[172:175], a[252:255], v[76:79]
s_waitcnt vmcnt(20)
v_mfma_f32_16x16x32_bf16 v[48:51], v[176:179], v[224:227], v[48:51]
v_mfma_f32_16x16x32_bf16 v[52:55], v[176:179], v[228:231], v[52:55]
buffer_load_dwordx4 v[168:171], v4, s[8:11], s31 offen
v_mfma_f32_16x16x32_bf16 v[56:59], v[176:179], v[232:235], v[56:59]
v_mfma_f32_16x16x32_bf16 v[60:63], v[176:179], v[236:239], v[60:63]
v_mfma_f32_16x16x32_bf16 v[64:67], v[180:183], v[224:227], v[64:67]
v_mfma_f32_16x16x32_bf16 v[68:71], v[180:183], v[228:231], v[68:71]
buffer_load_dwordx4 v[172:175], v4, s[12:15], s31 offen
s_add_u32 s31, s31, 1024
v_mfma_f32_16x16x32_bf16 v[72:75], v[180:183], v[232:235], v[72:75]
v_mfma_f32_16x16x32_bf16 v[76:79], v[180:183], v[236:239], v[76:79]
s_waitcnt vmcnt(20)
v_mfma_f32_16x16x32_bf16 v[48:51], v[184:187], v[240:243], v[48:51]
v_mfma_f32_16x16x32_bf16 v[52:55], v[184:187], v[244:247], v[52:55]
buffer_load_dwordx4 v[176:179], v4, s[8:11], s31 offen
v_mfma_f32_16x16x32_bf16 v[56:59], v[184:187], v[248:251], v[56:59]
v_mfma_f32_16x16x32_bf16 v[60:63], v[184:187], v[252:255], v[60:63]
v_mfma_f32_16x16x32_bf16 v[64:67], v[188:191], v[240:243], v[64:67]
v_mfma_f32_16x16x32_bf16 v[68:71], v[188:191], v[244:247], v[68:71]
buffer_load_dwordx4 v[180:183], v4, s[12:15], s31 offen
s_add_u32 s31, s31, 1024
v_mfma_f32_16x16x32_bf16 v[72:75], v[188:191], v[248:251], v[72:75]
v_mfma_f32_16x16x32_bf16 v[76:79], v[188:191], v[252:255], v[76:79]
s_cmp_eq_u32 s37, 4
s_cbranch_scc0 ffn_kernel_c3
v_mov_b32 v14, 0
v_mov_b32 v15, 1
s_mov_b64 s[50:51], exec
s_mov_b64 exec, 1
buffer_atomic_add v15, v14, s[52:55], s32 offen
s_mov_b64 exec, s[50:51]
ffn_kernel_c3:
s_sub_u32 s37, s37, 1
s_cmp_eq_u32 s37, 0
s_cbranch_scc1 ffn_kernel_l1x
s_waitcnt vmcnt(20)
v_mfma_f32_16x16x32_bf16 v[16:19], v[96:99], a[0:3], 0
v_mfma_f32_16x16x32_bf16 v[20:23], v[96:99], a[4:7], 0
buffer_load_dwordx4 v[184:187], v4, s[8:11], s31 offen
v_mfma_f32_16x16x32_bf16 v[24:27], v[96:99], a[8:11], 0
v_mfma_f32_16x16x32_bf16 v[28:31], v[96:99], a[12:15], 0
v_mfma_f32_16x16x32_bf16 v[32:35], v[100:103], a[0:3], 0
v_mfma_f32_16x16x32_bf16 v[36:39], v[100:103], a[4:7], 0
buffer_load_dwordx4 v[188:191], v4, s[12:15], s31 offen
s_add_u32 s31, s31, 1024
v_mfma_f32_16x16x32_bf16 v[40:43], v[100:103], a[8:11], 0
v_mfma_f32_16x16x32_bf16 v[44:47], v[100:103], a[12:15], 0
s_waitcnt vmcnt(20)
v_mfma_f32_16x16x32_bf16 v[16:19], v[104:107], a[16:19], v[16:19]
v_mul_f32 v80, s39, v48
v_mul_f32 v81, s39, v49
v_mfma_f32_16x16x32_bf16 v[20:23], v[104:107], a[20:23], v[20:23]
buffer_load_dwordx4 v[96:99], v4, s[8:11], s31 offen
v_mfma_f32_16x16x32_bf16 v[24:27], v[104:107], a[24:27], v[24:27]
v_exp_f32 v80, v80
v_mfma_f32_16x16x32_bf16 v[28:31], v[104:107], a[28:31], v[28:31]
v_exp_f32 v81, v81
v_mfma_f32_16x16x32_bf16 v[32:35], v[108:111], a[16:19], v[32:35]
v_mul_f32 v82, v48, v64
v_mul_f32 v83, v49, v65
v_mfma_f32_16x16x32_bf16 v[36:39], v[108:111], a[20:23], v[36:39]
buffer_load_dwordx4 v[100:103], v4, s[12:15], s31 offen
s_add_u32 s31, s31, 1024
v_mfma_f32_16x16x32_bf16 v[40:43], v[108:111], a[24:27], v[40:43]
v_add_f32 v80, 1.0, v80
v_add_f32 v81, 1.0, v81
v_mfma_f32_16x16x32_bf16 v[44:47], v[108:111], a[28:31], v[44:47]
v_rcp_f32 v80, v80
s_waitcnt vmcnt(20)
v_mfma_f32_16x16x32_bf16 v[16:19], v[112:115], a[32:35], v[16:19]
v_rcp_f32 v81, v81
v_mfma_f32_16x16x32_bf16 v[20:23], v[112:115], a[36:39], v[20:23]
buffer_load_dwordx4 v[104:107], v4, s[8:11], s31 offen
v_mul_f32 v82, v82, v80
v_mfma_f32_16x16x32_bf16 v[24:27], v[112:115], a[40:43], v[24:27]
v_mul_f32 v83, v83, v81
v_cvt_pk_bf16_f32 v88, v82, v83
v_mfma_f32_16x16x32_bf16 v[28:31], v[112:115], a[44:47], v[28:31]
v_mul_f32 v84, s39, v50
v_mul_f32 v85, s39, v51
v_mfma_f32_16x16x32_bf16 v[32:35], v[116:119], a[32:35], v[32:35]
v_exp_f32 v84, v84
v_mfma_f32_16x16x32_bf16 v[36:39], v[116:119], a[36:39], v[36:39]
buffer_load_dwordx4 v[108:111], v4, s[12:15], s31 offen
s_add_u32 s31, s31, 1024
v_mfma_f32_16x16x32_bf16 v[40:43], v[116:119], a[40:43], v[40:43]
v_exp_f32 v85, v85
v_mfma_f32_16x16x32_bf16 v[44:47], v[116:119], a[44:47], v[44:47]
v_mul_f32 v86, v50, v66
v_mul_f32 v87, v51, v67
s_waitcnt vmcnt(20)
v_mfma_f32_16x16x32_bf16 v[16:19], v[120:123], a[48:51], v[16:19]
v_add_f32 v84, 1.0, v84
v_add_f32 v85, 1.0, v85
v_mfma_f32_16x16x32_bf16 v[20:23], v[120:123], a[52:55], v[20:23]
buffer_load_dwordx4 v[112:115], v4, s[8:11], s31 offen
v_mfma_f32_16x16x32_bf16 v[24:27], v[120:123], a[56:59], v[24:27]
v_rcp_f32 v84, v84
v_mfma_f32_16x16x32_bf16 v[28:31], v[120:123], a[60:63], v[28:31]
v_rcp_f32 v85, v85
v_mfma_f32_16x16x32_bf16 v[32:35], v[124:127], a[48:51], v[32:35]
v_mul_f32 v86, v86, v84
v_mul_f32 v87, v87, v85
v_mfma_f32_16x16x32_bf16 v[36:39], v[124:127], a[52:55], v[36:39]
buffer_load_dwordx4 v[116:119], v4, s[12:15], s31 offen
s_add_u32 s31, s31, 1024
v_mfma_f32_16x16x32_bf16 v[40:43], v[124:127], a[56:59], v[40:43]
v_cvt_pk_bf16_f32 v89, v86, v87
ds_write_b64 v5, v[88:89] offset:0
v_mfma_f32_16x16x32_bf16 v[44:47], v[124:127], a[60:63], v[44:47]
v_mul_f32 v80, s39, v52
v_mul_f32 v81, s39, v53
s_waitcnt vmcnt(20)
v_mfma_f32_16x16x32_bf16 v[16:19], v[128:131], a[64:67], v[16:19]
v_exp_f32 v80, v80
v_mfma_f32_16x16x32_bf16 v[20:23], v[128:131], a[68:71], v[20:23]
buffer_load_dwordx4 v[120:123], v4, s[8:11], s31 offen
v_mfma_f32_16x16x32_bf16 v[24:27], v[128:131], a[72:75], v[24:27]
v_exp_f32 v81, v81
v_mfma_f32_16x16x32_bf16 v[28:31], v[128:131], a[76:79], v[28:31]
v_mul_f32 v82, v52, v68
v_mul_f32 v83, v53, v69
v_mfma_f32_16x16x32_bf16 v[32:35], v[132:135], a[64:67], v[32:35]
v_add_f32 v80, 1.0, v80
v_add_f32 v81, 1.0, v81
v_mfma_f32_16x16x32_bf16 v[36:39], v[132:135], a[68:71], v[36:39]
buffer_load_dwordx4 v[124:127], v4, s[12:15], s31 offen
s_add_u32 s31, s31, 1024
v_mfma_f32_16x16x32_bf16 v[40:43], v[132:135], a[72:75], v[40:43]
v_rcp_f32 v80, v80
v_mfma_f32_16x16x32_bf16 v[44:47], v[132:135], a[76:79], v[44:47]
v_rcp_f32 v81, v81
s_waitcnt vmcnt(20)
v_mfma_f32_16x16x32_bf16 v[16:19], v[136:139], a[80:83], v[16:19]
v_mul_f32 v82, v82, v80
v_mul_f32 v83, v83, v81
v_mfma_f32_16x16x32_bf16 v[20:23], v[136:139], a[84:87], v[20:23]
buffer_load_dwordx4 v[128:131], v4, s[8:11], s31 offen
v_cvt_pk_bf16_f32 v90, v82, v83
v_mfma_f32_16x16x32_bf16 v[24:27], v[136:139], a[88:91], v[24:27]
v_mul_f32 v84, s39, v54
v_mul_f32 v85, s39, v55
v_mfma_f32_16x16x32_bf16 v[28:31], v[136:139], a[92:95], v[28:31]
v_exp_f32 v84, v84
v_mfma_f32_16x16x32_bf16 v[32:35], v[140:143], a[80:83], v[32:35]
v_exp_f32 v85, v85
v_mfma_f32_16x16x32_bf16 v[36:39], v[140:143], a[84:87], v[36:39]
buffer_load_dwordx4 v[132:135], v4, s[12:15], s31 offen
s_add_u32 s31, s31, 1024
v_mfma_f32_16x16x32_bf16 v[40:43], v[140:143], a[88:91], v[40:43]
v_mul_f32 v86, v54, v70
v_mul_f32 v87, v55, v71
v_mfma_f32_16x16x32_bf16 v[44:47], v[140:143], a[92:95], v[44:47]
v_add_f32 v84, 1.0, v84
v_add_f32 v85, 1.0, v85
s_waitcnt vmcnt(20)
v_mfma_f32_16x16x32_bf16 v[16:19], v[144:147], a[96:99], v[16:19]
v_rcp_f32 v84, v84
v_mfma_f32_16x16x32_bf16 v[20:23], v[144:147], a[100:103], v[20:23]
buffer_load_dwordx4 v[136:139], v4, s[8:11], s31 offen
v_mfma_f32_16x16x32_bf16 v[24:27], v[144:147], a[104:107], v[24:27]
v_rcp_f32 v85, v85
v_mfma_f32_16x16x32_bf16 v[28:31], v[144:147], a[108:111], v[28:31]
v_mul_f32 v86, v86, v84
v_mul_f32 v87, v87, v85
v_mfma_f32_16x16x32_bf16 v[32:35], v[148:151], a[96:99], v[32:35]
v_cvt_pk_bf16_f32 v91, v86, v87
ds_write_b64 v5, v[90:91] offset:1024
v_mfma_f32_16x16x32_bf16 v[36:39], v[148:151], a[100:103], v[36:39]
buffer_load_dwordx4 v[140:143], v4, s[12:15], s31 offen
s_add_u32 s31, s31, 1024
v_mfma_f32_16x16x32_bf16 v[40:43], v[148:151], a[104:107], v[40:43]
v_mul_f32 v80, s39, v56
v_mul_f32 v81, s39, v57
v_mfma_f32_16x16x32_bf16 v[44:47], v[148:151], a[108:111], v[44:47]
v_exp_f32 v80, v80
s_waitcnt vmcnt(20)
v_mfma_f32_16x16x32_bf16 v[16:19], v[152:155], a[112:115], v[16:19]
v_exp_f32 v81, v81
v_mfma_f32_16x16x32_bf16 v[20:23], v[152:155], a[116:119], v[20:23]
buffer_load_dwordx4 v[144:147], v4, s[8:11], s31 offen
v_mul_f32 v82, v56, v72
v_mfma_f32_16x16x32_bf16 v[24:27], v[152:155], a[120:123], v[24:27]
v_mul_f32 v83, v57, v73
v_add_f32 v80, 1.0, v80
v_mfma_f32_16x16x32_bf16 v[28:31], v[152:155], a[124:127], v[28:31]
v_add_f32 v81, 1.0, v81
v_mfma_f32_16x16x32_bf16 v[32:35], v[156:159], a[112:115], v[32:35]
v_rcp_f32 v80, v80
v_mfma_f32_16x16x32_bf16 v[36:39], v[156:159], a[116:119], v[36:39]
buffer_load_dwordx4 v[148:151], v4, s[12:15], s31 offen
s_add_u32 s31, s31, 1024
v_mfma_f32_16x16x32_bf16 v[40:43], v[156:159], a[120:123], v[40:43]
v_rcp_f32 v81, v81
v_mfma_f32_16x16x32_bf16 v[44:47], v[156:159], a[124:127], v[44:47]
v_mul_f32 v82, v82, v80
v_mul_f32 v83, v83, v81
s_waitcnt vmcnt(20)
v_mfma_f32_16x16x32_bf16 v[16:19], v[160:163], a[128:131], v[16:19]
v_cvt_pk_bf16_f32 v92, v82, v83
v_mul_f32 v84, s39, v58
v_mfma_f32_16x16x32_bf16 v[20:23], v[160:163], a[132:135], v[20:23]
buffer_load_dwordx4 v[152:155], v4, s[8:11], s31 offen
v_mul_f32 v85, s39, v59
v_mfma_f32_16x16x32_bf16 v[24:27], v[160:163], a[136:139], v[24:27]
v_exp_f32 v84, v84
v_mfma_f32_16x16x32_bf16 v[28:31], v[160:163], a[140:143], v[28:31]
v_exp_f32 v85, v85
v_mfma_f32_16x16x32_bf16 v[32:35], v[164:167], a[128:131], v[32:35]
v_mul_f32 v86, v58, v74
v_mul_f32 v87, v59, v75
v_mfma_f32_16x16x32_bf16 v[36:39], v[164:167], a[132:135], v[36:39]
buffer_load_dwordx4 v[156:159], v4, s[12:15], s31 offen
s_add_u32 s31, s31, 1024
v_mfma_f32_16x16x32_bf16 v[40:43], v[164:167], a[136:139], v[40:43]
v_add_f32 v84, 1.0, v84
v_add_f32 v85, 1.0, v85
v_mfma_f32_16x16x32_bf16 v[44:47], v[164:167], a[140:143], v[44:47]
v_rcp_f32 v84, v84
s_waitcnt vmcnt(20)
v_mfma_f32_16x16x32_bf16 v[16:19], v[168:171], a[144:147], v[16:19]
v_rcp_f32 v85, v85
v_mfma_f32_16x16x32_bf16 v[20:23], v[168:171], a[148:151], v[20:23]
buffer_load_dwordx4 v[160:163], v4, s[8:11], s31 offen
v_mul_f32 v86, v86, v84
v_mfma_f32_16x16x32_bf16 v[24:27], v[168:171], a[152:155], v[24:27]
v_mul_f32 v87, v87, v85
v_cvt_pk_bf16_f32 v93, v86, v87
v_mfma_f32_16x16x32_bf16 v[28:31], v[168:171], a[156:159], v[28:31]
ds_write_b64 v5, v[92:93] offset:2048
v_mul_f32 v80, s39, v60
v_mfma_f32_16x16x32_bf16 v[32:35], v[172:175], a[144:147], v[32:35]
v_mul_f32 v81, s39, v61
v_mfma_f32_16x16x32_bf16 v[36:39], v[172:175], a[148:151], v[36:39]
buffer_load_dwordx4 v[164:167], v4, s[12:15], s31 offen
s_add_u32 s31, s31, 1024
v_mfma_f32_16x16x32_bf16 v[40:43], v[172:175], a[152:155], v[40:43]
v_exp_f32 v80, v80
v_mfma_f32_16x16x32_bf16 v[44:47], v[172:175], a[156:159], v[44:47]
v_exp_f32 v81, v81
s_waitcnt vmcnt(20)
v_mfma_f32_16x16x32_bf16 v[16:19], v[176:179], a[160:163], v[16:19]
v_mul_f32 v82, v60, v76
v_mul_f32 v83, v61, v77
v_mfma_f32_16x16x32_bf16 v[20:23], v[176:179], a[164:167], v[20:23]
buffer_load_dwordx4 v[168:171], v4, s[8:11], s31 offen
v_add_f32 v80, 1.0, v80
v_mfma_f32_16x16x32_bf16 v[24:27], v[176:179], a[168:171], v[24:27]
v_add_f32 v81, 1.0, v81
v_mfma_f32_16x16x32_bf16 v[28:31], v[176:179], a[172:175], v[28:31]
v_rcp_f32 v80, v80
v_mfma_f32_16x16x32_bf16 v[32:35], v[180:183], a[160:163], v[32:35]
v_rcp_f32 v81, v81
v_mfma_f32_16x16x32_bf16 v[36:39], v[180:183], a[164:167], v[36:39]
buffer_load_dwordx4 v[172:175], v4, s[12:15], s31 offen
s_add_u32 s31, s31, 1024
v_mfma_f32_16x16x32_bf16 v[40:43], v[180:183], a[168:171], v[40:43]
v_mul_f32 v82, v82, v80
v_mul_f32 v83, v83, v81
v_mfma_f32_16x16x32_bf16 v[44:47], v[180:183], a[172:175], v[44:47]
v_cvt_pk_bf16_f32 v94, v82, v83
v_mul_f32 v84, s39, v62
s_waitcnt vmcnt(20)
v_mfma_f32_16x16x32_bf16 v[16:19], v[184:187], a[176:179], v[16:19]
v_mul_f32 v85, s39, v63
v_mfma_f32_16x16x32_bf16 v[20:23], v[184:187], a[180:183], v[20:23]
buffer_load_dwordx4 v[176:179], v4, s[8:11], s31 offen
v_mfma_f32_16x16x32_bf16 v[24:27], v[184:187], a[184:187], v[24:27]
v_exp_f32 v84, v84
v_mfma_f32_16x16x32_bf16 v[28:31], v[184:187], a[188:191], v[28:31]
v_exp_f32 v85, v85
v_mfma_f32_16x16x32_bf16 v[32:35], v[188:191], a[176:179], v[32:35]
v_mul_f32 v86, v62, v78
v_mul_f32 v87, v63, v79
v_mfma_f32_16x16x32_bf16 v[36:39], v[188:191], a[180:183], v[36:39]
buffer_load_dwordx4 v[180:183], v4, s[12:15], s31 offen
s_add_u32 s31, s31, 1024
v_mfma_f32_16x16x32_bf16 v[40:43], v[188:191], a[184:187], v[40:43]
v_add_f32 v84, 1.0, v84
v_add_f32 v85, 1.0, v85
v_mfma_f32_16x16x32_bf16 v[44:47], v[188:191], a[188:191], v[44:47]
v_rcp_f32 v84, v84
s_waitcnt vmcnt(20)
v_mfma_f32_16x16x32_bf16 v[16:19], v[96:99], a[192:195], v[16:19]
v_rcp_f32 v85, v85
v_mfma_f32_16x16x32_bf16 v[20:23], v[96:99], a[196:199], v[20:23]
buffer_load_dwordx4 v[184:187], v4, s[8:11], s31 offen
v_mul_f32 v86, v86, v84
v_mfma_f32_16x16x32_bf16 v[24:27], v[96:99], a[200:203], v[24:27]
v_mul_f32 v87, v87, v85
v_cvt_pk_bf16_f32 v95, v86, v87
v_mfma_f32_16x16x32_bf16 v[28:31], v[96:99], a[204:207], v[28:31]
ds_write_b64 v5, v[94:95] offset:3072
v_add_u32 v5, 0x2000, v5
v_mfma_f32_16x16x32_bf16 v[32:35], v[100:103], a[192:195], v[32:35]
v_mfma_f32_16x16x32_bf16 v[36:39], v[100:103], a[196:199], v[36:39]
buffer_load_dwordx4 v[188:191], v4, s[12:15], s31 offen
s_add_u32 s31, s31, 1024
v_mfma_f32_16x16x32_bf16 v[40:43], v[100:103], a[200:203], v[40:43]
v_mfma_f32_16x16x32_bf16 v[44:47], v[100:103], a[204:207], v[44:47]
s_waitcnt vmcnt(20)
v_mfma_f32_16x16x32_bf16 v[16:19], v[104:107], a[208:211], v[16:19]
v_mfma_f32_16x16x32_bf16 v[20:23], v[104:107], a[212:215], v[20:23]
buffer_load_dwordx4 v[96:99], v4, s[8:11], s31 offen
v_mfma_f32_16x16x32_bf16 v[24:27], v[104:107], a[216:219], v[24:27]
v_mfma_f32_16x16x32_bf16 v[28:31], v[104:107], a[220:223], v[28:31]
v_mfma_f32_16x16x32_bf16 v[32:35], v[108:111], a[208:211], v[32:35]
v_mfma_f32_16x16x32_bf16 v[36:39], v[108:111], a[212:215], v[36:39]
buffer_load_dwordx4 v[100:103], v4, s[12:15], s31 offen
s_add_u32 s31, s31, 1024
v_mfma_f32_16x16x32_bf16 v[40:43], v[108:111], a[216:219], v[40:43]
v_mfma_f32_16x16x32_bf16 v[44:47], v[108:111], a[220:223], v[44:47]
s_waitcnt vmcnt(20)
v_mfma_f32_16x16x32_bf16 v[16:19], v[112:115], a[224:227], v[16:19]
v_mfma_f32_16x16x32_bf16 v[20:23], v[112:115], a[228:231], v[20:23]
buffer_load_dwordx4 v[104:107], v4, s[8:11], s31 offen
v_mfma_f32_16x16x32_bf16 v[24:27], v[112:115], a[232:235], v[24:27]
v_mfma_f32_16x16x32_bf16 v[28:31], v[112:115], a[236:239], v[28:31]
v_mfma_f32_16x16x32_bf16 v[32:35], v[116:119], a[224:227], v[32:35]
v_mfma_f32_16x16x32_bf16 v[36:39], v[116:119], a[228:231], v[36:39]
buffer_load_dwordx4 v[108:111], v4, s[12:15], s31 offen
s_add_u32 s31, s31, 1024
v_mfma_f32_16x16x32_bf16 v[40:43], v[116:119], a[232:235], v[40:43]
v_mfma_f32_16x16x32_bf16 v[44:47], v[116:119], a[236:239], v[44:47]
s_waitcnt vmcnt(20)
v_mfma_f32_16x16x32_bf16 v[16:19], v[120:123], a[240:243], v[16:19]
v_mfma_f32_16x16x32_bf16 v[20:23], v[120:123], a[244:247], v[20:23]
buffer_load_dwordx4 v[112:115], v4, s[8:11], s31 offen
v_mfma_f32_16x16x32_bf16 v[24:27], v[120:123], a[248:251], v[24:27]
v_mfma_f32_16x16x32_bf16 v[28:31], v[120:123], a[252:255], v[28:31]
v_mfma_f32_16x16x32_bf16 v[32:35], v[124:127], a[240:243], v[32:35]
v_mfma_f32_16x16x32_bf16 v[36:39], v[124:127], a[244:247], v[36:39]
buffer_load_dwordx4 v[116:119], v4, s[12:15], s31 offen
s_add_u32 s31, s31, 1024
v_mfma_f32_16x16x32_bf16 v[40:43], v[124:127], a[248:251], v[40:43]
v_mfma_f32_16x16x32_bf16 v[44:47], v[124:127], a[252:255], v[44:47]
s_waitcnt vmcnt(20)
v_mfma_f32_16x16x32_bf16 v[16:19], v[128:131], v[224:227], v[16:19]
v_mfma_f32_16x16x32_bf16 v[20:23], v[128:131], v[228:231], v[20:23]
buffer_load_dwordx4 v[120:123], v4, s[8:11], s31 offen
v_mfma_f32_16x16x32_bf16 v[24:27], v[128:131], v[232:235], v[24:27]
v_mfma_f32_16x16x32_bf16 v[28:31], v[128:131], v[236:239], v[28:31]
v_mfma_f32_16x16x32_bf16 v[32:35], v[132:135], v[224:227], v[32:35]
v_mfma_f32_16x16x32_bf16 v[36:39], v[132:135], v[228:231], v[36:39]
buffer_load_dwordx4 v[124:127], v4, s[12:15], s31 offen
s_add_u32 s31, s31, 1024
v_mfma_f32_16x16x32_bf16 v[40:43], v[132:135], v[232:235], v[40:43]
v_mfma_f32_16x16x32_bf16 v[44:47], v[132:135], v[236:239], v[44:47]
s_waitcnt vmcnt(20)
v_mfma_f32_16x16x32_bf16 v[16:19], v[136:139], v[240:243], v[16:19]
v_mfma_f32_16x16x32_bf16 v[20:23], v[136:139], v[244:247], v[20:23]
buffer_load_dwordx4 v[128:131], v4, s[8:11], s31 offen
v_mfma_f32_16x16x32_bf16 v[24:27], v[136:139], v[248:251], v[24:27]
v_mfma_f32_16x16x32_bf16 v[28:31], v[136:139], v[252:255], v[28:31]
v_mfma_f32_16x16x32_bf16 v[32:35], v[140:143], v[240:243], v[32:35]
v_mfma_f32_16x16x32_bf16 v[36:39], v[140:143], v[244:247], v[36:39]
buffer_load_dwordx4 v[132:135], v4, s[12:15], s31 offen
s_add_u32 s31, s31, 1024
v_mfma_f32_16x16x32_bf16 v[40:43], v[140:143], v[248:251], v[40:43]
v_mfma_f32_16x16x32_bf16 v[44:47], v[140:143], v[252:255], v[44:47]
s_branch ffn_kernel_l1
ffn_kernel_l1x:
s_waitcnt lgkmcnt(0)
s_cmp_eq_u32 s58, 128
s_cbranch_scc1 ffn_kernel_w3_ok
s_mov_b32 s48, 20000
v_mov_b32 v14, 0
ffn_kernel_w3_poll:
buffer_load_dword v15, v14, s[52:55], s32 offen sc1
s_waitcnt vmcnt(0)
v_readfirstlane_b32 s49, v15
s_nop 3
s_cmp_eq_u32 s49, 128
s_cbranch_scc1 ffn_kernel_w3_ok
s_sub_u32 s48, s48, 1
s_cmp_eq_u32 s48, 0
s_cbranch_scc1 ffn_kernel_w3_ok
s_sleep 2
s_branch ffn_kernel_w3_poll
ffn_kernel_w3_ok:
s_waitcnt vmcnt(20)
v_mfma_f32_16x16x32_bf16 v[16:19], v[96:99], a[0:3], 0
v_mfma_f32_16x16x32_bf16 v[20:23], v[96:99], a[4:7], 0
buffer_load_dwordx4 v[184:187], v4, s[8:11], s31 offen
v_mfma_f32_16x16x32_bf16 v[24:27], v[96:99], a[8:11], 0
v_mfma_f32_16x16x32_bf16 v[28:31], v[96:99], a[12:15], 0
v_mfma_f32_16x16x32_bf16 v[32:35], v[100:103], a[0:3], 0
v_mfma_f32_16x16x32_bf16 v[36:39], v[100:103], a[4:7], 0
buffer_load_dwordx4 v[188:191], v4, s[12:15], s31 offen
s_add_u32 s31, s31, 1024
v_mfma_f32_16x16x32_bf16 v[40:43], v[100:103], a[8:11], 0
v_mfma_f32_16x16x32_bf16 v[44:47], v[100:103], a[12:15], 0
s_waitcnt vmcnt(20)
v_mfma_f32_16x16x32_bf16 v[16:19], v[104:107], a[16:19], v[16:19]
v_mul_f32 v80, s39, v48
v_mul_f32 v81, s39, v49
v_mfma_f32_16x16x32_bf16 v[20:23], v[104:107], a[20:23], v[20:23]
buffer_load_dwordx4 v[96:99], v4, s[8:11], s31 offen
v_mfma_f32_16x16x32_bf16 v[24:27], v[104:107], a[24:27], v[24:27]
v_exp_f32 v80, v80
v_mfma_f32_16x16x32_bf16 v[28:31], v[104:107], a[28:31], v[28:31]
v_exp_f32 v81, v81
v_mfma_f32_16x16x32_bf16 v[32:35], v[108:111], a[16:19], v[32:35]
v_mul_f32 v82, v48, v64
v_mul_f32 v83, v49, v65
v_mfma_f32_16x16x32_bf16 v[36:39], v[108:111], a[20:23], v[36:39]
buffer_load_dwordx4 v[100:103], v4, s[12:15], s31 offen
s_add_u32 s31, s31, 1024
v_mfma_f32_16x16x32_bf16 v[40:43], v[108:111], a[24:27], v[40:43]
v_add_f32 v80, 1.0, v80
v_add_f32 v81, 1.0, v81
v_mfma_f32_16x16x32_bf16 v[44:47], v[108:111], a[28:31], v[44:47]
v_rcp_f32 v80, v80
s_waitcnt vmcnt(20)
v_mfma_f32_16x16x32_bf16 v[16:19], v[112:115], a[32:35], v[16:19]
v_rcp_f32 v81, v81
v_mfma_f32_16x16x32_bf16 v[20:23], v[112:115], a[36:39], v[20:23]
buffer_load_dwordx4 v[104:107], v4, s[8:11], s31 offen
v_mul_f32 v82, v82, v80
v_mfma_f32_16x16x32_bf16 v[24:27], v[112:115], a[40:43], v[24:27]
v_mul_f32 v83, v83, v81
v_cvt_pk_bf16_f32 v88, v82, v83
v_mfma_f32_16x16x32_bf16 v[28:31], v[112:115], a[44:47], v[28:31]
v_mul_f32 v84, s39, v50
v_mul_f32 v85, s39, v51
v_mfma_f32_16x16x32_bf16 v[32:35], v[116:119], a[32:35], v[32:35]
v_exp_f32 v84, v84
v_mfma_f32_16x16x32_bf16 v[36:39], v[116:119], a[36:39], v[36:39]
buffer_load_dwordx4 v[108:111], v4, s[12:15], s31 offen
s_add_u32 s31, s31, 1024
v_mfma_f32_16x16x32_bf16 v[40:43], v[116:119], a[40:43], v[40:43]
v_exp_f32 v85, v85
v_mfma_f32_16x16x32_bf16 v[44:47], v[116:119], a[44:47], v[44:47]
v_mul_f32 v86, v50, v66
v_mul_f32 v87, v51, v67
s_waitcnt vmcnt(20)
v_mfma_f32_16x16x32_bf16 v[16:19], v[120:123], a[48:51], v[16:19]
v_add_f32 v84, 1.0, v84
v_add_f32 v85, 1.0, v85
v_mfma_f32_16x16x32_bf16 v[20:23], v[120:123], a[52:55], v[20:23]
buffer_load_dwordx4 v[112:115], v4, s[8:11], s31 offen
v_mfma_f32_16x16x32_bf16 v[24:27], v[120:123], a[56:59], v[24:27]
v_rcp_f32 v84, v84
v_mfma_f32_16x16x32_bf16 v[28:31], v[120:123], a[60:63], v[28:31]
v_rcp_f32 v85, v85
v_mfma_f32_16x16x32_bf16 v[32:35], v[124:127], a[48:51], v[32:35]
v_mul_f32 v86, v86, v84
v_mul_f32 v87, v87, v85
v_mfma_f32_16x16x32_bf16 v[36:39], v[124:127], a[52:55], v[36:39]
buffer_load_dwordx4 v[116:119], v4, s[12:15], s31 offen
s_add_u32 s31, s31, 1024
v_mfma_f32_16x16x32_bf16 v[40:43], v[124:127], a[56:59], v[40:43]
v_cvt_pk_bf16_f32 v89, v86, v87
ds_write_b64 v5, v[88:89] offset:0
v_mfma_f32_16x16x32_bf16 v[44:47], v[124:127], a[60:63], v[44:47]
v_mul_f32 v80, s39, v52
v_mul_f32 v81, s39, v53
s_waitcnt vmcnt(20)
v_mfma_f32_16x16x32_bf16 v[16:19], v[128:131], a[64:67], v[16:19]
v_exp_f32 v80, v80
v_mfma_f32_16x16x32_bf16 v[20:23], v[128:131], a[68:71], v[20:23]
buffer_load_dwordx4 v[120:123], v4, s[8:11], s31 offen
v_mfma_f32_16x16x32_bf16 v[24:27], v[128:131], a[72:75], v[24:27]
v_exp_f32 v81, v81
v_mfma_f32_16x16x32_bf16 v[28:31], v[128:131], a[76:79], v[28:31]
v_mul_f32 v82, v52, v68
v_mul_f32 v83, v53, v69
v_mfma_f32_16x16x32_bf16 v[32:35], v[132:135], a[64:67], v[32:35]
v_add_f32 v80, 1.0, v80
v_add_f32 v81, 1.0, v81
v_mfma_f32_16x16x32_bf16 v[36:39], v[132:135], a[68:71], v[36:39]
buffer_load_dwordx4 v[124:127], v4, s[12:15], s31 offen
s_add_u32 s31, s31, 1024
v_mfma_f32_16x16x32_bf16 v[40:43], v[132:135], a[72:75], v[40:43]
v_rcp_f32 v80, v80
v_mfma_f32_16x16x32_bf16 v[44:47], v[132:135], a[76:79], v[44:47]
v_rcp_f32 v81, v81
s_waitcnt vmcnt(20)
v_mfma_f32_16x16x32_bf16 v[16:19], v[136:139], a[80:83], v[16:19]
v_mul_f32 v82, v82, v80
v_mul_f32 v83, v83, v81
v_mfma_f32_16x16x32_bf16 v[20:23], v[136:139], a[84:87], v[20:23]
buffer_load_dwordx4 v[128:131], v4, s[8:11], s31 offen
v_cvt_pk_bf16_f32 v90, v82, v83
v_mfma_f32_16x16x32_bf16 v[24:27], v[136:139], a[88:91], v[24:27]
v_mul_f32 v84, s39, v54
v_mul_f32 v85, s39, v55
v_mfma_f32_16x16x32_bf16 v[28:31], v[136:139], a[92:95], v[28:31]
v_exp_f32 v84, v84
v_mfma_f32_16x16x32_bf16 v[32:35], v[140:143], a[80:83], v[32:35]
v_exp_f32 v85, v85
v_mfma_f32_16x16x32_bf16 v[36:39], v[140:143], a[84:87], v[36:39]
buffer_load_dwordx4 v[132:135], v4, s[12:15], s31 offen
s_add_u32 s31, s31, 1024
v_mfma_f32_16x16x32_bf16 v[40:43], v[140:143], a[88:91], v[40:43]
v_mul_f32 v86, v54, v70
v_mul_f32 v87, v55, v71
v_mfma_f32_16x16x32_bf16 v[44:47], v[140:143], a[92:95], v[44:47]
v_add_f32 v84, 1.0, v84
v_add_f32 v85, 1.0, v85
s_waitcnt vmcnt(20)
v_mfma_f32_16x16x32_bf16 v[16:19], v[144:147], a[96:99], v[16:19]
v_rcp_f32 v84, v84
v_mfma_f32_16x16x32_bf16 v[20:23], v[144:147], a[100:103], v[20:23]
buffer_load_dwordx4 v[136:139], v4, s[8:11], s31 offen
v_mfma_f32_16x16x32_bf16 v[24:27], v[144:147], a[104:107], v[24:27]
v_rcp_f32 v85, v85
v_mfma_f32_16x16x32_bf16 v[28:31], v[144:147], a[108:111], v[28:31]
v_mul_f32 v86, v86, v84
v_mul_f32 v87, v87, v85
v_mfma_f32_16x16x32_bf16 v[32:35], v[148:151], a[96:99], v[32:35]
v_cvt_pk_bf16_f32 v91, v86, v87
ds_write_b64 v5, v[90:91] offset:1024
v_mfma_f32_16x16x32_bf16 v[36:39], v[148:151], a[100:103], v[36:39]
buffer_load_dwordx4 v[140:143], v4, s[12:15], s31 offen
s_add_u32 s31, s31, 1024
v_mfma_f32_16x16x32_bf16 v[40:43], v[148:151], a[104:107], v[40:43]
v_mul_f32 v80, s39, v56
v_mul_f32 v81, s39, v57
v_mfma_f32_16x16x32_bf16 v[44:47], v[148:151], a[108:111], v[44:47]
v_exp_f32 v80, v80
s_waitcnt vmcnt(20)
v_mfma_f32_16x16x32_bf16 v[16:19], v[152:155], a[112:115], v[16:19]
v_exp_f32 v81, v81
v_mfma_f32_16x16x32_bf16 v[20:23], v[152:155], a[116:119], v[20:23]
buffer_load_dwordx4 v[144:147], v4, s[16:19], s35 offen sc1
s_add_u32 s35, s35, 1024
v_mfma_f32_16x16x32_bf16 v[24:27], v[152:155], a[120:123], v[24:27]
v_mul_f32 v82, v56, v72
v_mul_f32 v83, v57, v73
v_mfma_f32_16x16x32_bf16 v[28:31], v[152:155], a[124:127], v[28:31]
v_add_f32 v80, 1.0, v80
v_add_f32 v81, 1.0, v81
v_mfma_f32_16x16x32_bf16 v[32:35], v[156:159], a[112:115], v[32:35]
v_rcp_f32 v80, v80
v_mfma_f32_16x16x32_bf16 v[36:39], v[156:159], a[116:119], v[36:39]
buffer_load_dwordx4 v[148:151], v4, s[16:19], s35 offen sc1
s_add_u32 s35, s35, 1024
v_mfma_f32_16x16x32_bf16 v[40:43], v[156:159], a[120:123], v[40:43]
v_rcp_f32 v81, v81
v_mfma_f32_16x16x32_bf16 v[44:47], v[156:159], a[124:127], v[44:47]
v_mul_f32 v82, v82, v80
v_mul_f32 v83, v83, v81
s_waitcnt vmcnt(20)
v_mfma_f32_16x16x32_bf16 v[16:19], v[160:163], a[128:131], v[16:19]
v_cvt_pk_bf16_f32 v92, v82, v83
v_mul_f32 v84, s39, v58
v_mfma_f32_16x16x32_bf16 v[20:23], v[160:163], a[132:135], v[20:23]
buffer_load_dwordx4 v[152:155], v4, s[16:19], s35 offen sc1
s_add_u32 s35, s35, 1024
v_mfma_f32_16x16x32_bf16 v[24:27], v[160:163], a[136:139], v[24:27]
v_mul_f32 v85, s39, v59
v_mfma_f32_16x16x32_bf16 v[28:31], v[160:163], a[140:143], v[28:31]
v_exp_f32 v84, v84
v_mfma_f32_16x16x32_bf16 v[32:35], v[164:167], a[128:131], v[32:35]
v_exp_f32 v85, v85
v_mfma_f32_16x16x32_bf16 v[36:39], v[164:167], a[132:135], v[36:39]
buffer_load_dwordx4 v[156:159], v4, s[16:19], s35 offen sc1
s_add_u32 s35, s35, 1024
v_mfma_f32_16x16x32_bf16 v[40:43], v[164:167], a[136:139], v[40:43]
v_mul_f32 v86, v58, v74
v_mul_f32 v87, v59, v75
v_mfma_f32_16x16x32_bf16 v[44:47], v[164:167], a[140:143], v[44:47]
v_add_f32 v84, 1.0, v84
v_add_f32 v85, 1.0, v85
s_waitcnt vmcnt(20)
v_mfma_f32_16x16x32_bf16 v[16:19], v[168:171], a[144:147], v[16:19]
v_rcp_f32 v84, v84
v_mfma_f32_16x16x32_bf16 v[20:23], v[168:171], a[148:151], v[20:23]
buffer_load_dwordx4 v[160:163], v4, s[16:19], s35 offen sc1
s_add_u32 s35, s35, 1024
v_mfma_f32_16x16x32_bf16 v[24:27], v[168:171], a[152:155], v[24:27]
v_rcp_f32 v85, v85
v_mfma_f32_16x16x32_bf16 v[28:31], v[168:171], a[156:159], v[28:31]
v_mul_f32 v86, v86, v84
v_mul_f32 v87, v87, v85
v_mfma_f32_16x16x32_bf16 v[32:35], v[172:175], a[144:147], v[32:35]
v_cvt_pk_bf16_f32 v93, v86, v87
ds_write_b64 v5, v[92:93] offset:2048
v_mfma_f32_16x16x32_bf16 v[36:39], v[172:175], a[148:151], v[36:39]
buffer_load_dwordx4 v[164:167], v4, s[16:19], s35 offen sc1
s_add_u32 s35, s35, 1024
v_mfma_f32_16x16x32_bf16 v[40:43], v[172:175], a[152:155], v[40:43]
v_mul_f32 v80, s39, v60
v_mul_f32 v81, s39, v61
v_mfma_f32_16x16x32_bf16 v[44:47], v[172:175], a[156:159], v[44:47]
v_exp_f32 v80, v80
s_waitcnt vmcnt(20)
v_mfma_f32_16x16x32_bf16 v[16:19], v[176:179], a[160:163], v[16:19]
v_exp_f32 v81, v81
v_mfma_f32_16x16x32_bf16 v[20:23], v[176:179], a[164:167], v[20:23]
buffer_load_dwordx4 v[168:171], v4, s[16:19], s35 offen sc1
s_add_u32 s35, s35, 1024
v_mfma_f32_16x16x32_bf16 v[24:27], v[176:179], a[168:171], v[24:27]
v_mul_f32 v82, v60, v76
v_mul_f32 v83, v61, v77
v_mfma_f32_16x16x32_bf16 v[28:31], v[176:179], a[172:175], v[28:31]
v_add_f32 v80, 1.0, v80
v_add_f32 v81, 1.0, v81
v_mfma_f32_16x16x32_bf16 v[32:35], v[180:183], a[160:163], v[32:35]
v_rcp_f32 v80, v80
v_mfma_f32_16x16x32_bf16 v[36:39], v[180:183], a[164:167], v[36:39]
buffer_load_dwordx4 v[172:175], v4, s[16:19], s35 offen sc1
s_add_u32 s35, s35, 1024
v_mfma_f32_16x16x32_bf16 v[40:43], v[180:183], a[168:171], v[40:43]
v_rcp_f32 v81, v81
v_mfma_f32_16x16x32_bf16 v[44:47], v[180:183], a[172:175], v[44:47]
v_mul_f32 v82, v82, v80
v_mul_f32 v83, v83, v81
s_waitcnt vmcnt(20)
v_mfma_f32_16x16x32_bf16 v[16:19], v[184:187], a[176:179], v[16:19]
v_cvt_pk_bf16_f32 v94, v82, v83
v_mul_f32 v84, s39, v62
v_mfma_f32_16x16x32_bf16 v[20:23], v[184:187], a[180:183], v[20:23]
buffer_load_dwordx4 v[176:179], v4, s[16:19], s35 offen sc1
s_add_u32 s35, s35, 1024
v_mfma_f32_16x16x32_bf16 v[24:27], v[184:187], a[184:187], v[24:27]
v_mul_f32 v85, s39, v63
v_mfma_f32_16x16x32_bf16 v[28:31], v[184:187], a[188:191], v[28:31]
v_exp_f32 v84, v84
v_mfma_f32_16x16x32_bf16 v[32:35], v[188:191], a[176:179], v[32:35]
v_exp_f32 v85, v85
v_mfma_f32_16x16x32_bf16 v[36:39], v[188:191], a[180:183], v[36:39]
buffer_load_dwordx4 v[180:183], v4, s[16:19], s35 offen sc1
s_add_u32 s35, s35, 1024
v_mfma_f32_16x16x32_bf16 v[40:43], v[188:191], a[184:187], v[40:43]
v_mul_f32 v86, v62, v78
v_mul_f32 v87, v63, v79
v_mfma_f32_16x16x32_bf16 v[44:47], v[188:191], a[188:191], v[44:47]
v_add_f32 v84, 1.0, v84
v_add_f32 v85, 1.0, v85
s_waitcnt vmcnt(20)
v_mfma_f32_16x16x32_bf16 v[16:19], v[96:99], a[192:195], v[16:19]
v_rcp_f32 v84, v84
v_mfma_f32_16x16x32_bf16 v[20:23], v[96:99], a[196:199], v[20:23]
buffer_load_dwordx4 v[184:187], v4, s[16:19], s35 offen sc1
s_add_u32 s35, s35, 1024
v_mfma_f32_16x16x32_bf16 v[24:27], v[96:99], a[200:203], v[24:27]
v_rcp_f32 v85, v85
v_mfma_f32_16x16x32_bf16 v[28:31], v[96:99], a[204:207], v[28:31]
v_mul_f32 v86, v86, v84
v_mul_f32 v87, v87, v85
v_mfma_f32_16x16x32_bf16 v[32:35], v[100:103], a[192:195], v[32:35]
v_cvt_pk_bf16_f32 v95, v86, v87
ds_write_b64 v5, v[94:95] offset:3072
v_mfma_f32_16x16x32_bf16 v[36:39], v[100:103], a[196:199], v[36:39]
buffer_load_dwordx4 v[188:191], v4, s[16:19], s35 offen sc1
s_add_u32 s35, s35, 1024
v_mfma_f32_16x16x32_bf16 v[40:43], v[100:103], a[200:203], v[40:43]
v_add_u32 v5, 0x2000, v5
v_mfma_f32_16x16x32_bf16 v[44:47], v[100:103], a[204:207], v[44:47]
s_waitcnt vmcnt(20)
v_mfma_f32_16x16x32_bf16 v[16:19], v[104:107], a[208:211], v[16:19]
v_mfma_f32_16x16x32_bf16 v[20:23], v[104:107], a[212:215], v[20:23]
buffer_load_dwordx4 v[96:99], v4, s[16:19], s35 offen sc1
s_add_u32 s35, s35, 1024
v_mfma_f32_16x16x32_bf16 v[24:27], v[104:107], a[216:219], v[24:27]
v_mfma_f32_16x16x32_bf16 v[28:31], v[104:107], a[220:223], v[28:31]
v_mfma_f32_16x16x32_bf16 v[32:35], v[108:111], a[208:211], v[32:35]
v_mfma_f32_16x16x32_bf16 v[36:39], v[108:111], a[212:215], v[36:39]
buffer_load_dwordx4 v[100:103], v4, s[16:19], s35 offen sc1
s_add_u32 s35, s35, 1024
v_mfma_f32_16x16x32_bf16 v[40:43], v[108:111], a[216:219], v[40:43]
v_mfma_f32_16x16x32_bf16 v[44:47], v[108:111], a[220:223], v[44:47]
s_waitcnt vmcnt(20)
v_mfma_f32_16x16x32_bf16 v[16:19], v[112:115], a[224:227], v[16:19]
v_mfma_f32_16x16x32_bf16 v[20:23], v[112:115], a[228:231], v[20:23]
buffer_load_dwordx4 v[104:107], v4, s[16:19], s35 offen sc1
s_add_u32 s35, s35, 1024
v_mfma_f32_16x16x32_bf16 v[24:27], v[112:115], a[232:235], v[24:27]
v_mfma_f32_16x16x32_bf16 v[28:31], v[112:115], a[236:239], v[28:31]
v_mfma_f32_16x16x32_bf16 v[32:35], v[116:119], a[224:227], v[32:35]
v_mfma_f32_16x16x32_bf16 v[36:39], v[116:119], a[228:231], v[36:39]
buffer_load_dwordx4 v[108:111], v4, s[16:19], s35 offen sc1
s_add_u32 s35, s35, 1024
v_mfma_f32_16x16x32_bf16 v[40:43], v[116:119], a[232:235], v[40:43]
v_mfma_f32_16x16x32_bf16 v[44:47], v[116:119], a[236:239], v[44:47]
s_waitcnt vmcnt(20)
v_mfma_f32_16x16x32_bf16 v[16:19], v[120:123], a[240:243], v[16:19]
v_mfma_f32_16x16x32_bf16 v[20:23], v[120:123], a[244:247], v[20:23]
buffer_load_dwordx4 v[112:115], v4, s[16:19], s35 offen sc1
s_add_u32 s35, s35, 1024
v_mfma_f32_16x16x32_bf16 v[24:27], v[120:123], a[248:251], v[24:27]
v_mfma_f32_16x16x32_bf16 v[28:31], v[120:123], a[252:255], v[28:31]
v_mfma_f32_16x16x32_bf16 v[32:35], v[124:127], a[240:243], v[32:35]
v_mfma_f32_16x16x32_bf16 v[36:39], v[124:127], a[244:247], v[36:39]
buffer_load_dwordx4 v[116:119], v4, s[16:19], s35 offen sc1
s_add_u32 s35, s35, 1024
v_mfma_f32_16x16x32_bf16 v[40:43], v[124:127], a[248:251], v[40:43]
v_mfma_f32_16x16x32_bf16 v[44:47], v[124:127], a[252:255], v[44:47]
s_waitcnt vmcnt(20)
v_mfma_f32_16x16x32_bf16 v[16:19], v[128:131], v[224:227], v[16:19]
v_mfma_f32_16x16x32_bf16 v[20:23], v[128:131], v[228:231], v[20:23]
v_mfma_f32_16x16x32_bf16 v[24:27], v[128:131], v[232:235], v[24:27]
v_mfma_f32_16x16x32_bf16 v[28:31], v[128:131], v[236:239], v[28:31]
v_mfma_f32_16x16x32_bf16 v[32:35], v[132:135], v[224:227], v[32:35]
v_mfma_f32_16x16x32_bf16 v[36:39], v[132:135], v[228:231], v[36:39]
v_mfma_f32_16x16x32_bf16 v[40:43], v[132:135], v[232:235], v[40:43]
v_mfma_f32_16x16x32_bf16 v[44:47], v[132:135], v[236:239], v[44:47]
s_waitcnt vmcnt(18)
v_mfma_f32_16x16x32_bf16 v[16:19], v[136:139], v[240:243], v[16:19]
v_mfma_f32_16x16x32_bf16 v[20:23], v[136:139], v[244:247], v[20:23]
v_mfma_f32_16x16x32_bf16 v[24:27], v[136:139], v[248:251], v[24:27]
v_mfma_f32_16x16x32_bf16 v[28:31], v[136:139], v[252:255], v[28:31]
v_mfma_f32_16x16x32_bf16 v[32:35], v[140:143], v[240:243], v[32:35]
v_mfma_f32_16x16x32_bf16 v[36:39], v[140:143], v[244:247], v[36:39]
v_mfma_f32_16x16x32_bf16 v[40:43], v[140:143], v[248:251], v[40:43]
v_mfma_f32_16x16x32_bf16 v[44:47], v[140:143], v[252:255], v[44:47]
s_nop 4
v_mul_f32 v80, s39, v16
v_mul_f32 v81, s39, v17
v_exp_f32 v80, v80
v_exp_f32 v81, v81
v_mul_f32 v82, v16, v32
v_mul_f32 v83, v17, v33
v_add_f32 v80, 1.0, v80
v_add_f32 v81, 1.0, v81
v_rcp_f32 v80, v80
v_rcp_f32 v81, v81
v_mul_f32 v82, v82, v80
v_mul_f32 v83, v83, v81
v_cvt_pk_bf16_f32 v88, v82, v83
v_mul_f32 v84, s39, v18
v_mul_f32 v85, s39, v19
v_exp_f32 v84, v84
v_exp_f32 v85, v85
v_mul_f32 v86, v18, v34
v_mul_f32 v87, v19, v35
v_add_f32 v84, 1.0, v84
v_add_f32 v85, 1.0, v85
v_rcp_f32 v84, v84
v_rcp_f32 v85, v85
v_mul_f32 v86, v86, v84
v_mul_f32 v87, v87, v85
v_cvt_pk_bf16_f32 v89, v86, v87
ds_write_b64 v5, v[88:89] offset:0
v_mul_f32 v80, s39, v20
v_mul_f32 v81, s39, v21
v_exp_f32 v80, v80
v_exp_f32 v81, v81
v_mul_f32 v82, v20, v36
v_mul_f32 v83, v21, v37
v_add_f32 v80, 1.0, v80
v_add_f32 v81, 1.0, v81
v_rcp_f32 v80, v80
v_rcp_f32 v81, v81
v_mul_f32 v82, v82, v80
v_mul_f32 v83, v83, v81
v_cvt_pk_bf16_f32 v90, v82, v83
v_mul_f32 v84, s39, v22
v_mul_f32 v85, s39, v23
v_exp_f32 v84, v84
v_exp_f32 v85, v85
v_mul_f32 v86, v22, v38
v_mul_f32 v87, v23, v39
v_add_f32 v84, 1.0, v84
v_add_f32 v85, 1.0, v85
v_rcp_f32 v84, v84
v_rcp_f32 v85, v85
v_mul_f32 v86, v86, v84
v_mul_f32 v87, v87, v85
v_cvt_pk_bf16_f32 v91, v86, v87
ds_write_b64 v5, v[90:91] offset:1024
v_mul_f32 v80, s39, v24
v_mul_f32 v81, s39, v25
v_exp_f32 v80, v80
v_exp_f32 v81, v81
v_mul_f32 v82, v24, v40
v_mul_f32 v83, v25, v41
v_add_f32 v80, 1.0, v80
v_add_f32 v81, 1.0, v81
v_rcp_f32 v80, v80
v_rcp_f32 v81, v81
v_mul_f32 v82, v82, v80
v_mul_f32 v83, v83, v81
v_cvt_pk_bf16_f32 v92, v82, v83
v_mul_f32 v84, s39, v26
v_mul_f32 v85, s39, v27
v_exp_f32 v84, v84
v_exp_f32 v85, v85
v_mul_f32 v86, v26, v42
v_mul_f32 v87, v27, v43
v_add_f32 v84, 1.0, v84
v_add_f32 v85, 1.0, v85
v_rcp_f32 v84, v84
v_rcp_f32 v85, v85
v_mul_f32 v86, v86, v84
v_mul_f32 v87, v87, v85
v_cvt_pk_bf16_f32 v93, v86, v87
ds_write_b64 v5, v[92:93] offset:2048
v_mul_f32 v80, s39, v28
v_mul_f32 v81, s39, v29
v_exp_f32 v80, v80
v_exp_f32 v81, v81
v_mul_f32 v82, v28, v44
v_mul_f32 v83, v29, v45
v_add_f32 v80, 1.0, v80
v_add_f32 v81, 1.0, v81
v_rcp_f32 v80, v80
v_rcp_f32 v81, v81
v_mul_f32 v82, v82, v80
v_mul_f32 v83, v83, v81
v_cvt_pk_bf16_f32 v94, v82, v83
v_mul_f32 v84, s39, v30
v_mul_f32 v85, s39, v31
v_exp_f32 v84, v84
v_exp_f32 v85, v85
v_mul_f32 v86, v30, v46
v_mul_f32 v87, v31, v47
v_add_f32 v84, 1.0, v84
v_add_f32 v85, 1.0, v85
v_rcp_f32 v84, v84
v_rcp_f32 v85, v85
v_mul_f32 v86, v86, v84
v_mul_f32 v87, v87, v85
v_cvt_pk_bf16_f32 v95, v86, v87
ds_write_b64 v5, v[94:95] offset:3072
v_add_u32 v5, 0x2000, v5
s_lshl_b32 s48, s29, 3
s_add_u32 s48, s48, s30
s_mul_i32 s49, s48, 73728
s_add_u32 s48, s28, 0
s_mul_i32 s80, s48, 1024
s_add_u32 s80, s80, s49
s_cmp_lt_u32 s48, 9
s_cselect_b32 s80, s80, 0x70000000
s_add_u32 s48, s28, 4
s_mul_i32 s81, s48, 1024
s_add_u32 s81, s81, s49
s_cmp_lt_u32 s48, 9
s_cselect_b32 s81, s81, 0x70000000
s_add_u32 s48, s28, 8
s_mul_i32 s82, s48, 1024
s_add_u32 s82, s82, s49
s_cmp_lt_u32 s48, 9
s_cselect_b32 s82, s82, 0x70000000
s_lshl_b32 s59, s29, 7
s_add_u32 s59, s59, 12288
s_mov_b32 s33, 0
s_add_u32 s48, s59, 44302336
s_add_u32 s84, s46, s48
s_addc_u32 s85, s47, 0
s_mov_b32 s83, 0
s_waitcnt lgkmcnt(0)
s_barrier
ds_read_b128 a[0:3], v6 offset:0
ds_read_b128 a[4:7], v6 offset:1024
ds_read_b128 a[8:11], v6 offset:2048
ds_read_b128 a[12:15], v6 offset:3072
ds_read_b128 a[16:19], v6 offset:4096
ds_read_b128 a[20:23], v6 offset:5120
ds_read_b128 a[24:27], v6 offset:6144
ds_read_b128 a[28:31], v6 offset:7168
s_waitcnt lgkmcnt(4)
s_waitcnt vmcnt(17)
v_mfma_f32_16x16x32_bf16 v[16:19], v[144:147], a[0:3], 0
ds_read_b128 a[32:35], v6 offset:8192
ds_read_b128 a[36:39], v6 offset:9216
v_mfma_f32_16x16x32_bf16 v[20:23], v[144:147], a[4:7], 0
v_mfma_f32_16x16x32_bf16 v[24:27], v[144:147], a[8:11], 0
ds_read_b128 a[40:43], v6 offset:10240
ds_read_b128 a[44:47], v6 offset:11264
v_mfma_f32_16x16x32_bf16 v[28:31], v[144:147], a[12:15], 0
s_waitcnt lgkmcnt(4)
s_waitcnt vmcnt(16)
v_mfma_f32_16x16x32_bf16 v[16:19], v[148:151], a[16:19], v[16:19]
ds_read_b128 a[48:51], v6 offset:12288
ds_read_b128 a[52:55], v6 offset:13312
v_mfma_f32_16x16x32_bf16 v[20:23], v[148:151], a[20:23], v[20:23]
buffer_load_dwordx4 v[144:147], v4, s[16:19], s35 offen sc1
s_add_u32 s35, s35, 1024
v_mfma_f32_16x16x32_bf16 v[24:27], v[148:151], a[24:27], v[24:27]
ds_read_b128 a[56:59], v6 offset:14336
ds_read_b128 a[60:63], v6 offset:15360
v_mfma_f32_16x16x32_bf16 v[28:31], v[148:151], a[28:31], v[28:31]
s_waitcnt lgkmcnt(4)
s_waitcnt vmcnt(16)
v_mfma_f32_16x16x32_bf16 v[16:19], v[152:155], a[32:35], v[16:19]
ds_read_b128 a[64:67], v6 offset:16384
ds_read_b128 a[68:71], v6 offset:17408
v_mfma_f32_16x16x32_bf16 v[20:23], v[152:155], a[36:39], v[20:23]
buffer_load_dwordx4 v[148:151], v4, s[16:19], s35 offen sc1
s_add_u32 s35, s35, 1024
v_mfma_f32_16x16x32_bf16 v[24:27], v[152:155], a[40:43], v[24:27]
ds_read_b128 a[72:75], v6 offset:18432
ds_read_b128 a[76:79], v6 offset:19456
v_mfma_f32_16x16x32_bf16 v[28:31], v[152:155], a[44:47], v[28:31]
s_waitcnt lgkmcnt(4)
s_waitcnt vmcnt(16)
v_mfma_f32_16x16x32_bf16 v[16:19], v[156:159], a[48:51], v[16:19]
ds_read_b128 a[80:83], v6 offset:20480
ds_read_b128 a[84:87], v6 offset:21504
v_mfma_f32_16x16x32_bf16 v[20:23], v[156:159], a[52:55], v[20:23]
buffer_load_dwordx4 v[152:155], v4, s[16:19], s35 offen sc1
s_add_u32 s35, s35, 1024
v_mfma_f32_16x16x32_bf16 v[24:27], v[156:159], a[56:59], v[24:27]
ds_read_b128 a[88:91], v6 offset:22528
ds_read_b128 a[92:95], v6 offset:23552
v_mfma_f32_16x16x32_bf16 v[28:31], v[156:159], a[60:63], v[28:31]
s_waitcnt lgkmcnt(4)
s_waitcnt vmcnt(16)
v_mfma_f32_16x16x32_bf16 v[16:19], v[160:163], a[64:67], v[16:19]
ds_read_b128 a[96:99], v6 offset:24576
ds_read_b128 a[100:103], v6 offset:25600
v_mfma_f32_16x16x32_bf16 v[20:23], v[160:163], a[68:71], v[20:23]
buffer_load_dwordx4 v[156:159], v4, s[16:19], s35 offen sc1
s_add_u32 s35, s35, 1024
v_mfma_f32_16x16x32_bf16 v[24:27], v[160:163], a[72:75], v[24:27]
ds_read_b128 a[104:107], v6 offset:26624
ds_read_b128 a[108:111], v6 offset:27648
v_mfma_f32_16x16x32_bf16 v[28:31], v[160:163], a[76:79], v[28:31]
s_waitcnt lgkmcnt(4)
s_waitcnt vmcnt(16)
v_mfma_f32_16x16x32_bf16 v[16:19], v[164:167], a[80:83], v[16:19]
ds_read_b128 a[112:115], v6 offset:28672
ds_read_b128 a[116:119], v6 offset:29696
v_mfma_f32_16x16x32_bf16 v[20:23], v[164:167], a[84:87], v[20:23]
buffer_load_dwordx4 v[160:163], v4, s[16:19], s35 offen sc1
s_add_u32 s35, s35, 1024
v_mfma_f32_16x16x32_bf16 v[24:27], v[164:167], a[88:91], v[24:27]
ds_read_b128 a[120:123], v6 offset:30720
ds_read_b128 a[124:127], v6 offset:31744
v_mfma_f32_16x16x32_bf16 v[28:31], v[164:167], a[92:95], v[28:31]
s_waitcnt lgkmcnt(4)
s_waitcnt vmcnt(16)
v_mfma_f32_16x16x32_bf16 v[16:19], v[168:171], a[96:99], v[16:19]
ds_read_b128 a[128:131], v6 offset:32768
ds_read_b128 a[132:135], v6 offset:33792
v_mfma_f32_16x16x32_bf16 v[20:23], v[168:171], a[100:103], v[20:23]
buffer_load_dwordx4 v[164:167], v4, s[16:19], s35 offen sc1
s_add_u32 s35, s35, 1024
v_mfma_f32_16x16x32_bf16 v[24:27], v[168:171], a[104:107], v[24:27]
ds_read_b128 a[136:139], v6 offset:34816
ds_read_b128 a[140:143], v6 offset:35840
v_mfma_f32_16x16x32_bf16 v[28:31], v[168:171], a[108:111], v[28:31]
s_waitcnt lgkmcnt(4)
s_waitcnt vmcnt(16)
v_mfma_f32_16x16x32_bf16 v[16:19], v[172:175], a[112:115], v[16:19]
ds_read_b128 a[144:147], v6 offset:36864
ds_read_b128 a[148:151], v6 offset:37888
v_mfma_f32_16x16x32_bf16 v[20:23], v[172:175], a[116:119], v[20:23]
buffer_load_dwordx4 v[168:171], v4, s[16:19], s35 offen sc1
s_add_u32 s35, s35, 1024
v_mfma_f32_16x16x32_bf16 v[24:27], v[172:175], a[120:123], v[24:27]
ds_read_b128 a[152:155], v6 offset:38912
ds_read_b128 a[156:159], v6 offset:39936
v_mfma_f32_16x16x32_bf16 v[28:31], v[172:175], a[124:127], v[28:31]
s_waitcnt lgkmcnt(4)
s_waitcnt vmcnt(16)
v_mfma_f32_16x16x32_bf16 v[16:19], v[176:179], a[128:131], v[16:19]
ds_read_b128 a[160:163], v6 offset:40960
ds_read_b128 a[164:167], v6 offset:41984
v_mfma_f32_16x16x32_bf16 v[20:23], v[176:179], a[132:135], v[20:23]
buffer_load_dwordx4 v[172:175], v4, s[16:19], s35 offen sc1
s_add_u32 s35, s35, 1024
v_mfma_f32_16x16x32_bf16 v[24:27], v[176:179], a[136:139], v[24:27]
ds_read_b128 a[168:171], v6 offset:43008
ds_read_b128 a[172:175], v6 offset:44032
v_mfma_f32_16x16x32_bf16 v[28:31], v[176:179], a[140:143], v[28:31]
s_waitcnt lgkmcnt(4)
s_waitcnt vmcnt(16)
v_mfma_f32_16x16x32_bf16 v[16:19], v[180:183], a[144:147], v[16:19]
ds_read_b128 a[176:179], v6 offset:45056
ds_read_b128 a[180:183], v6 offset:46080
v_mfma_f32_16x16x32_bf16 v[20:23], v[180:183], a[148:151], v[20:23]
buffer_load_dwordx4 v[176:179], v4, s[16:19], s35 offen sc1
s_add_u32 s35, s35, 1024
v_mfma_f32_16x16x32_bf16 v[24:27], v[180:183], a[152:155], v[24:27]
ds_read_b128 a[184:187], v6 offset:47104
ds_read_b128 a[188:191], v6 offset:48128
v_mfma_f32_16x16x32_bf16 v[28:31], v[180:183], a[156:159], v[28:31]
s_waitcnt lgkmcnt(4)
s_waitcnt vmcnt(16)
v_mfma_f32_16x16x32_bf16 v[16:19], v[184:187], a[160:163], v[16:19]
ds_read_b128 a[192:195], v6 offset:49152
ds_read_b128 a[196:199], v6 offset:50176
v_mfma_f32_16x16x32_bf16 v[20:23], v[184:187], a[164:167], v[20:23]
buffer_load_dwordx4 v[180:183], v4, s[16:19], s35 offen sc1
s_add_u32 s35, s35, 1024
v_mfma_f32_16x16x32_bf16 v[24:27], v[184:187], a[168:171], v[24:27]
ds_read_b128 a[200:203], v6 offset:51200
ds_read_b128 a[204:207], v6 offset:52224
v_mfma_f32_16x16x32_bf16 v[28:31], v[184:187], a[172:175], v[28:31]
s_waitcnt lgkmcnt(4)
s_waitcnt vmcnt(16)
v_mfma_f32_16x16x32_bf16 v[16:19], v[188:191], a[176:179], v[16:19]
ds_read_b128 a[208:211], v6 offset:53248
ds_read_b128 a[212:215], v6 offset:54272
v_mfma_f32_16x16x32_bf16 v[20:23], v[188:191], a[180:183], v[20:23]
buffer_load_dwordx4 v[184:187], v4, s[16:19], s35 offen sc1
s_add_u32 s35, s35, 1024
v_mfma_f32_16x16x32_bf16 v[24:27], v[188:191], a[184:187], v[24:27]
ds_read_b128 a[216:219], v6 offset:55296
ds_read_b128 a[220:223], v6 offset:56320
v_mfma_f32_16x16x32_bf16 v[28:31], v[188:191], a[188:191], v[28:31]
s_waitcnt lgkmcnt(4)
s_waitcnt vmcnt(16)
v_mfma_f32_16x16x32_bf16 v[16:19], v[96:99], a[192:195], v[16:19]
ds_read_b128 a[224:227], v6 offset:57344
ds_read_b128 a[228:231], v6 offset:58368
v_mfma_f32_16x16x32_bf16 v[20:23], v[96:99], a[196:199], v[20:23]
buffer_load_dwordx4 v[188:191], v4, s[16:19], s35 offen sc1
s_add_u32 s35, s35, 1024
v_mfma_f32_16x16x32_bf16 v[24:27], v[96:99], a[200:203], v[24:27]
ds_read_b128 a[232:235], v6 offset:59392
ds_read_b128 a[236:239], v6 offset:60416
v_mfma_f32_16x16x32_bf16 v[28:31], v[96:99], a[204:207], v[28:31]
s_waitcnt lgkmcnt(4)
s_waitcnt vmcnt(16)
v_mfma_f32_16x16x32_bf16 v[16:19], v[100:103], a[208:211], v[16:19]
ds_read_b128 a[240:243], v6 offset:61440
ds_read_b128 a[244:247], v6 offset:62464
v_mfma_f32_16x16x32_bf16 v[20:23], v[100:103], a[212:215], v[20:23]
buffer_load_dwordx4 v[96:99], v4, s[16:19], s35 offen sc1
s_add_u32 s35, s35, 1024
v_mfma_f32_16x16x32_bf16 v[24:27], v[100:103], a[216:219], v[24:27]
ds_read_b128 a[248:251], v6 offset:63488
ds_read_b128 a[252:255], v6 offset:64512
v_mfma_f32_16x16x32_bf16 v[28:31], v[100:103], a[220:223], v[28:31]
s_waitcnt lgkmcnt(4)
s_waitcnt vmcnt(16)
v_mfma_f32_16x16x32_bf16 v[16:19], v[104:107], a[224:227], v[16:19]
ds_read_b128 v[224:227], v7 offset:0
ds_read_b128 v[228:231], v7 offset:1024
v_mfma_f32_16x16x32_bf16 v[20:23], v[104:107], a[228:231], v[20:23]
buffer_load_dwordx4 v[100:103], v4, s[16:19], s35 offen sc1
s_add_u32 s35, s35, 1024
v_mfma_f32_16x16x32_bf16 v[24:27], v[104:107], a[232:235], v[24:27]
ds_read_b128 v[232:235], v7 offset:2048
ds_read_b128 v[236:239], v7 offset:3072
v_mfma_f32_16x16x32_bf16 v[28:31], v[104:107], a[236:239], v[28:31]
s_waitcnt lgkmcnt(4)
s_waitcnt vmcnt(16)
v_mfma_f32_16x16x32_bf16 v[16:19], v[108:111], a[240:243], v[16:19]
ds_read_b128 v[240:243], v7 offset:4096
ds_read_b128 v[244:247], v7 offset:5120
v_mfma_f32_16x16x32_bf16 v[20:23], v[108:111], a[244:247], v[20:23]
buffer_load_dwordx4 v[104:107], v4, s[16:19], s35 offen sc1
s_add_u32 s35, s35, 1024
v_mfma_f32_16x16x32_bf16 v[24:27], v[108:111], a[248:251], v[24:27]
ds_read_b128 v[248:251], v7 offset:6144
ds_read_b128 v[252:255], v7 offset:7168
v_mfma_f32_16x16x32_bf16 v[28:31], v[108:111], a[252:255], v[28:31]
s_waitcnt lgkmcnt(4)
s_waitcnt vmcnt(16)
v_mfma_f32_16x16x32_bf16 v[16:19], v[112:115], v[224:227], v[16:19]
v_mfma_f32_16x16x32_bf16 v[20:23], v[112:115], v[228:231], v[20:23]
buffer_load_dwordx4 v[108:111], v4, s[16:19], s35 offen sc1
s_add_u32 s35, s35, 1024
v_mfma_f32_16x16x32_bf16 v[24:27], v[112:115], v[232:235], v[24:27]
v_mfma_f32_16x16x32_bf16 v[28:31], v[112:115], v[236:239], v[28:31]
s_waitcnt lgkmcnt(0)
s_waitcnt vmcnt(16)
v_mfma_f32_16x16x32_bf16 v[16:19], v[116:119], v[240:243], v[16:19]
v_mfma_f32_16x16x32_bf16 v[20:23], v[116:119], v[244:247], v[20:23]
buffer_load_dwordx4 v[112:115], v4, s[16:19], s35 offen sc1
s_add_u32 s35, s35, 1024
v_mfma_f32_16x16x32_bf16 v[24:27], v[116:119], v[248:251], v[24:27]
v_mfma_f32_16x16x32_bf16 v[28:31], v[116:119], v[252:255], v[28:31]
s_mov_b32 s37, 3
ffn_kernel_l2:
s_waitcnt vmcnt(16)
v_mfma_f32_16x16x32_bf16 v[48:51], v[144:147], a[0:3], 0
v_mfma_f32_16x16x32_bf16 v[52:55], v[144:147], a[4:7], 0
buffer_load_dwordx4 v[116:119], v4, s[16:19], s35 offen sc1
s_add_u32 s35, s35, 1024
v_mfma_f32_16x16x32_bf16 v[56:59], v[144:147], a[8:11], 0
v_mfma_f32_16x16x32_bf16 v[60:63], v[144:147], a[12:15], 0
s_waitcnt vmcnt(16)
v_mfma_f32_16x16x32_bf16 v[48:51], v[148:151], a[16:19], v[48:51]
v_mfma_f32_16x16x32_bf16 v[52:55], v[148:151], a[20:23], v[52:55]
buffer_load_dwordx4 v[144:147], v4, s[16:19], s35 offen sc1
s_add_u32 s35, s35, 1024
v_mfma_f32_16x16x32_bf16 v[56:59], v[148:151], a[24:27], v[56:59]
v_cvt_pk_bf16_f32 v88, v16, v17
v_mfma_f32_16x16x32_bf16 v[60:63], v[148:151], a[28:31], v[60:63]
v_cvt_pk_bf16_f32 v89, v18, v19
s_waitcnt vmcnt(16)
v_mfma_f32_16x16x32_bf16 v[48:51], v[152:155], a[32:35], v[48:51]
v_mfma_f32_16x16x32_bf16 v[52:55], v[152:155], a[36:39], v[52:55]
buffer_load_dwordx4 v[148:151], v4, s[16:19], s35 offen sc1
s_add_u32 s35, s35, 1024
v_mfma_f32_16x16x32_bf16 v[56:59], v[152:155], a[40:43], v[56:59]
v_cvt_pk_bf16_f32 v90, v20, v21
v_mfma_f32_16x16x32_bf16 v[60:63], v[152:155], a[44:47], v[60:63]
v_cvt_pk_bf16_f32 v91, v22, v23
s_waitcnt vmcnt(16)
v_mfma_f32_16x16x32_bf16 v[48:51], v[156:159], a[48:51], v[48:51]
v_mfma_f32_16x16x32_bf16 v[52:55], v[156:159], a[52:55], v[52:55]
buffer_load_dwordx4 v[152:155], v4, s[16:19], s35 offen sc1
s_add_u32 s35, s35, 1024
v_mfma_f32_16x16x32_bf16 v[56:59], v[156:159], a[56:59], v[56:59]
v_permlane16_swap_b32 v88, v90
v_mfma_f32_16x16x32_bf16 v[60:63], v[156:159], a[60:63], v[60:63]
v_permlane16_swap_b32 v89, v91
s_waitcnt vmcnt(16)
v_mfma_f32_16x16x32_bf16 v[48:51], v[160:163], a[64:67], v[48:51]
v_mfma_f32_16x16x32_bf16 v[52:55], v[160:163], a[68:71], v[52:55]
buffer_load_dwordx4 v[156:159], v4, s[16:19], s35 offen sc1
s_add_u32 s35, s35, 1024
v_mfma_f32_16x16x32_bf16 v[56:59], v[160:163], a[72:75], v[56:59]
buffer_store_dwordx4 v[88:91], v8, s[24:27], s36 offen sc1
v_mfma_f32_16x16x32_bf16 v[60:63], v[160:163], a[76:79], v[60:63]
ds_write_b128 v10, v[88:91]
s_waitcnt vmcnt(17)
v_mfma_f32_16x16x32_bf16 v[48:51], v[164:167], a[80:83], v[48:51]
v_mfma_f32_16x16x32_bf16 v[52:55], v[164:167], a[84:87], v[52:55]
buffer_load_dwordx4 v[160:163], v4, s[16:19], s35 offen sc1
s_add_u32 s35, s35, 1024
v_mfma_f32_16x16x32_bf16 v[56:59], v[164:167], a[88:91], v[56:59]
s_add_u32 s36, s36, 1024
v_mfma_f32_16x16x32_bf16 v[60:63], v[164:167], a[92:95], v[60:63]
v_add_u32 v10, 0x400, v10
s_waitcnt vmcnt(17)
v_mfma_f32_16x16x32_bf16 v[48:51], v[168:171], a[96:99], v[48:51]
v_mfma_f32_16x16x32_bf16 v[52:55], v[168:171], a[100:103], v[52:55]
buffer_load_dwordx4 v[164:167], v4, s[16:19], s35 offen sc1
s_add_u32 s35, s35, 1024
v_mfma_f32_16x16x32_bf16 v[56:59], v[168:171], a[104:107], v[56:59]
v_cvt_pk_bf16_f32 v92, v24, v25
v_mfma_f32_16x16x32_bf16 v[60:63], v[168:171], a[108:111], v[60:63]
v_cvt_pk_bf16_f32 v93, v26, v27
s_waitcnt vmcnt(17)
v_mfma_f32_16x16x32_bf16 v[48:51], v[172:175], a[112:115], v[48:51]
v_mfma_f32_16x16x32_bf16 v[52:55], v[172:175], a[116:119], v[52:55]
buffer_load_dwordx4 v[168:171], v4, s[16:19], s35 offen sc1
s_add_u32 s35, s35, 1024
v_mfma_f32_16x16x32_bf16 v[56:59], v[172:175], a[120:123], v[56:59]
v_cvt_pk_bf16_f32 v94, v28, v29
v_mfma_f32_16x16x32_bf16 v[60:63], v[172:175], a[124:127], v[60:63]
v_cvt_pk_bf16_f32 v95, v30, v31
s_waitcnt vmcnt(17)
v_mfma_f32_16x16x32_bf16 v[48:51], v[176:179], a[128:131], v[48:51]
v_mfma_f32_16x16x32_bf16 v[52:55], v[176:179], a[132:135], v[52:55]
buffer_load_dwordx4 v[172:175], v4, s[16:19], s35 offen sc1
s_add_u32 s35, s35, 1024
v_mfma_f32_16x16x32_bf16 v[56:59], v[176:179], a[136:139], v[56:59]
v_permlane16_swap_b32 v92, v94
v_mfma_f32_16x16x32_bf16 v[60:63], v[176:179], a[140:143], v[60:63]
v_permlane16_swap_b32 v93, v95
s_waitcnt vmcnt(17)
v_mfma_f32_16x16x32_bf16 v[48:51], v[180:183], a[144:147], v[48:51]
v_mfma_f32_16x16x32_bf16 v[52:55], v[180:183], a[148:151], v[52:55]
buffer_load_dwordx4 v[176:179], v4, s[16:19], s35 offen sc1
s_add_u32 s35, s35, 1024
v_mfma_f32_16x16x32_bf16 v[56:59], v[180:183], a[152:155], v[56:59]
buffer_store_dwordx4 v[92:95], v9, s[24:27], s40 offen sc1
v_mfma_f32_16x16x32_bf16 v[60:63], v[180:183], a[156:159], v[60:63]
ds_write_b128 v11, v[92:95]
s_waitcnt vmcnt(18)
v_mfma_f32_16x16x32_bf16 v[48:51], v[184:187], a[160:163], v[48:51]
v_mfma_f32_16x16x32_bf16 v[52:55], v[184:187], a[164:167], v[52:55]
buffer_load_dwordx4 v[180:183], v4, s[16:19], s35 offen sc1
s_add_u32 s35, s35, 1024
v_mfma_f32_16x16x32_bf16 v[56:59], v[184:187], a[168:171], v[56:59]
s_add_u32 s40, s40, 1024
v_mfma_f32_16x16x32_bf16 v[60:63], v[184:187], a[172:175], v[60:63]
v_add_u32 v11, 0x400, v11
s_waitcnt vmcnt(18)
v_mfma_f32_16x16x32_bf16 v[48:51], v[188:191], a[176:179], v[48:51]
v_mfma_f32_16x16x32_bf16 v[52:55], v[188:191], a[180:183], v[52:55]
buffer_load_dwordx4 v[184:187], v4, s[16:19], s35 offen sc1
s_add_u32 s35, s35, 1024
v_mfma_f32_16x16x32_bf16 v[56:59], v[188:191], a[184:187], v[56:59]
v_mfma_f32_16x16x32_bf16 v[60:63], v[188:191], a[188:191], v[60:63]
s_waitcnt vmcnt(18)
v_mfma_f32_16x16x32_bf16 v[48:51], v[96:99], a[192:195], v[48:51]
v_mfma_f32_16x16x32_bf16 v[52:55], v[96:99], a[196:199], v[52:55]
buffer_load_dwordx4 v[188:191], v4, s[16:19], s35 offen sc1
s_add_u32 s35, s35, 1024
v_mfma_f32_16x16x32_bf16 v[56:59], v[96:99], a[200:203], v[56:59]
v_mfma_f32_16x16x32_bf16 v[60:63], v[96:99], a[204:207], v[60:63]
s_waitcnt vmcnt(18)
v_mfma_f32_16x16x32_bf16 v[48:51], v[100:103], a[208:211], v[48:51]
v_mfma_f32_16x16x32_bf16 v[52:55], v[100:103], a[212:215], v[52:55]
buffer_load_dwordx4 v[96:99], v4, s[16:19], s35 offen sc1
s_add_u32 s35, s35, 1024
v_mfma_f32_16x16x32_bf16 v[56:59], v[100:103], a[216:219], v[56:59]
v_mfma_f32_16x16x32_bf16 v[60:63], v[100:103], a[220:223], v[60:63]
s_waitcnt vmcnt(18)
v_mfma_f32_16x16x32_bf16 v[48:51], v[104:107], a[224:227], v[48:51]
v_mfma_f32_16x16x32_bf16 v[52:55], v[104:107], a[228:231], v[52:55]
buffer_load_dwordx4 v[100:103], v4, s[16:19], s35 offen sc1
s_add_u32 s35, s35, 1024
v_mfma_f32_16x16x32_bf16 v[56:59], v[104:107], a[232:235], v[56:59]
v_mfma_f32_16x16x32_bf16 v[60:63], v[104:107], a[236:239], v[60:63]
s_waitcnt vmcnt(18)
v_mfma_f32_16x16x32_bf16 v[48:51], v[108:111], a[240:243], v[48:51]
v_mfma_f32_16x16x32_bf16 v[52:55], v[108:111], a[244:247], v[52:55]
buffer_load_dwordx4 v[104:107], v4, s[16:19], s35 offen sc1
s_add_u32 s35, s35, 1024
v_mfma_f32_16x16x32_bf16 v[56:59], v[108:111], a[248:251], v[56:59]
v_mfma_f32_16x16x32_bf16 v[60:63], v[108:111], a[252:255], v[60:63]
s_waitcnt vmcnt(18)
v_mfma_f32_16x16x32_bf16 v[48:51], v[112:115], v[224:227], v[48:51]
v_mfma_f32_16x16x32_bf16 v[52:55], v[112:115], v[228:231], v[52:55]
buffer_load_dwordx4 v[108:111], v4, s[16:19], s35 offen sc1
s_add_u32 s35, s35, 1024
v_mfma_f32_16x16x32_bf16 v[56:59], v[112:115], v[232:235], v[56:59]
v_mfma_f32_16x16x32_bf16 v[60:63], v[112:115], v[236:239], v[60:63]
s_waitcnt vmcnt(18)
v_mfma_f32_16x16x32_bf16 v[48:51], v[116:119], v[240:243], v[48:51]
v_mfma_f32_16x16x32_bf16 v[52:55], v[116:119], v[244:247], v[52:55]
buffer_load_dwordx4 v[112:115], v4, s[16:19], s35 offen sc1
s_add_u32 s35, s35, 1024
v_mfma_f32_16x16x32_bf16 v[56:59], v[116:119], v[248:251], v[56:59]
v_mfma_f32_16x16x32_bf16 v[60:63], v[116:119], v[252:255], v[60:63]
s_waitcnt vmcnt(18)
v_mfma_f32_16x16x32_bf16 v[16:19], v[144:147], a[0:3], 0
v_mfma_f32_16x16x32_bf16 v[20:23], v[144:147], a[4:7], 0
buffer_load_dwordx4 v[116:119], v4, s[16:19], s35 offen sc1
s_add_u32 s35, s35, 1024
v_mfma_f32_16x16x32_bf16 v[24:27], v[144:147], a[8:11], 0
v_mfma_f32_16x16x32_bf16 v[28:31], v[144:147], a[12:15], 0
s_waitcnt vmcnt(18)
v_mfma_f32_16x16x32_bf16 v[16:19], v[148:151], a[16:19], v[16:19]
v_mfma_f32_16x16x32_bf16 v[20:23], v[148:151], a[20:23], v[20:23]
buffer_load_dwordx4 v[144:147], v4, s[16:19], s35 offen sc1
s_add_u32 s35, s35, 1024
v_mfma_f32_16x16x32_bf16 v[24:27], v[148:151], a[24:27], v[24:27]
v_cvt_pk_bf16_f32 v88, v48, v49
v_mfma_f32_16x16x32_bf16 v[28:31], v[148:151], a[28:31], v[28:31]
v_cvt_pk_bf16_f32 v89, v50, v51
s_waitcnt vmcnt(18)
v_mfma_f32_16x16x32_bf16 v[16:19], v[152:155], a[32:35], v[16:19]
v_mfma_f32_16x16x32_bf16 v[20:23], v[152:155], a[36:39], v[20:23]
buffer_load_dwordx4 v[148:151], v4, s[16:19], s35 offen sc1
s_add_u32 s35, s35, 1024
v_mfma_f32_16x16x32_bf16 v[24:27], v[152:155], a[40:43], v[24:27]
v_cvt_pk_bf16_f32 v90, v52, v53
v_mfma_f32_16x16x32_bf16 v[28:31], v[152:155], a[44:47], v[28:31]
v_cvt_pk_bf16_f32 v91, v54, v55
s_waitcnt vmcnt(18)
v_mfma_f32_16x16x32_bf16 v[16:19], v[156:159], a[48:51], v[16:19]
v_mfma_f32_16x16x32_bf16 v[20:23], v[156:159], a[52:55], v[20:23]
buffer_load_dwordx4 v[152:155], v4, s[16:19], s35 offen sc1
s_add_u32 s35, s35, 1024
v_mfma_f32_16x16x32_bf16 v[24:27], v[156:159], a[56:59], v[24:27]
v_permlane16_swap_b32 v88, v90
v_mfma_f32_16x16x32_bf16 v[28:31], v[156:159], a[60:63], v[28:31]
v_permlane16_swap_b32 v89, v91
s_waitcnt vmcnt(17)
v_mfma_f32_16x16x32_bf16 v[16:19], v[160:163], a[64:67], v[16:19]
v_mfma_f32_16x16x32_bf16 v[20:23], v[160:163], a[68:71], v[20:23]
buffer_load_dwordx4 v[156:159], v4, s[16:19], s35 offen sc1
s_add_u32 s35, s35, 1024
v_mfma_f32_16x16x32_bf16 v[24:27], v[160:163], a[72:75], v[24:27]
buffer_store_dwordx4 v[88:91], v8, s[24:27], s36 offen sc1
v_mfma_f32_16x16x32_bf16 v[28:31], v[160:163], a[76:79], v[28:31]
ds_write_b128 v10, v[88:91]
s_waitcnt vmcnt(18)
v_mfma_f32_16x16x32_bf16 v[16:19], v[164:167], a[80:83], v[16:19]
v_mfma_f32_16x16x32_bf16 v[20:23], v[164:167], a[84:87], v[20:23]
buffer_load_dwordx4 v[160:163], v4, s[16:19], s35 offen sc1
s_add_u32 s35, s35, 1024
v_mfma_f32_16x16x32_bf16 v[24:27], v[164:167], a[88:91], v[24:27]
s_add_u32 s36, s36, 1024
v_mfma_f32_16x16x32_bf16 v[28:31], v[164:167], a[92:95], v[28:31]
v_add_u32 v10, 0x400, v10
s_waitcnt vmcnt(18)
v_mfma_f32_16x16x32_bf16 v[16:19], v[168:171], a[96:99], v[16:19]
v_mfma_f32_16x16x32_bf16 v[20:23], v[168:171], a[100:103], v[20:23]
buffer_load_dwordx4 v[164:167], v4, s[16:19], s35 offen sc1
s_add_u32 s35, s35, 1024
v_mfma_f32_16x16x32_bf16 v[24:27], v[168:171], a[104:107], v[24:27]
v_cvt_pk_bf16_f32 v92, v56, v57
v_mfma_f32_16x16x32_bf16 v[28:31], v[168:171], a[108:111], v[28:31]
v_cvt_pk_bf16_f32 v93, v58, v59
s_waitcnt vmcnt(18)
v_mfma_f32_16x16x32_bf16 v[16:19], v[172:175], a[112:115], v[16:19]
v_mfma_f32_16x16x32_bf16 v[20:23], v[172:175], a[116:119], v[20:23]
buffer_load_dwordx4 v[168:171], v4, s[16:19], s35 offen sc1
s_add_u32 s35, s35, 1024
v_mfma_f32_16x16x32_bf16 v[24:27], v[172:175], a[120:123], v[24:27]
v_cvt_pk_bf16_f32 v94, v60, v61
v_mfma_f32_16x16x32_bf16 v[28:31], v[172:175], a[124:127], v[28:31]
v_cvt_pk_bf16_f32 v95, v62, v63
s_waitcnt vmcnt(18)
v_mfma_f32_16x16x32_bf16 v[16:19], v[176:179], a[128:131], v[16:19]
v_mfma_f32_16x16x32_bf16 v[20:23], v[176:179], a[132:135], v[20:23]
buffer_load_dwordx4 v[172:175], v4, s[16:19], s35 offen sc1
s_add_u32 s35, s35, 1024
v_mfma_f32_16x16x32_bf16 v[24:27], v[176:179], a[136:139], v[24:27]
v_permlane16_swap_b32 v92, v94
v_mfma_f32_16x16x32_bf16 v[28:31], v[176:179], a[140:143], v[28:31]
v_permlane16_swap_b32 v93, v95
s_waitcnt vmcnt(17)
v_mfma_f32_16x16x32_bf16 v[16:19], v[180:183], a[144:147], v[16:19]
v_mfma_f32_16x16x32_bf16 v[20:23], v[180:183], a[148:151], v[20:23]
buffer_load_dwordx4 v[176:179], v4, s[16:19], s35 offen sc1
s_add_u32 s35, s35, 1024
v_mfma_f32_16x16x32_bf16 v[24:27], v[180:183], a[152:155], v[24:27]
buffer_store_dwordx4 v[92:95], v9, s[24:27], s40 offen sc1
v_mfma_f32_16x16x32_bf16 v[28:31], v[180:183], a[156:159], v[28:31]
ds_write_b128 v11, v[92:95]
s_waitcnt vmcnt(18)
v_mfma_f32_16x16x32_bf16 v[16:19], v[184:187], a[160:163], v[16:19]
v_mfma_f32_16x16x32_bf16 v[20:23], v[184:187], a[164:167], v[20:23]
buffer_load_dwordx4 v[180:183], v4, s[16:19], s35 offen sc1
s_add_u32 s35, s35, 1024
v_mfma_f32_16x16x32_bf16 v[24:27], v[184:187], a[168:171], v[24:27]
s_add_u32 s40, s40, 1024
v_mfma_f32_16x16x32_bf16 v[28:31], v[184:187], a[172:175], v[28:31]
v_add_u32 v11, 0x400, v11
s_waitcnt vmcnt(18)
v_mfma_f32_16x16x32_bf16 v[16:19], v[188:191], a[176:179], v[16:19]
v_mfma_f32_16x16x32_bf16 v[20:23], v[188:191], a[180:183], v[20:23]
buffer_load_dwordx4 v[184:187], v4, s[16:19], s35 offen sc1
s_add_u32 s35, s35, 1024
v_mfma_f32_16x16x32_bf16 v[24:27], v[188:191], a[184:187], v[24:27]
v_mfma_f32_16x16x32_bf16 v[28:31], v[188:191], a[188:191], v[28:31]
s_waitcnt vmcnt(18)
v_mfma_f32_16x16x32_bf16 v[16:19], v[96:99], a[192:195], v[16:19]
v_mfma_f32_16x16x32_bf16 v[20:23], v[96:99], a[196:199], v[20:23]
buffer_load_dwordx4 v[188:191], v4, s[16:19], s35 offen sc1
s_add_u32 s35, s35, 1024
v_mfma_f32_16x16x32_bf16 v[24:27], v[96:99], a[200:203], v[24:27]
v_mfma_f32_16x16x32_bf16 v[28:31], v[96:99], a[204:207], v[28:31]
s_waitcnt vmcnt(18)
v_mfma_f32_16x16x32_bf16 v[16:19], v[100:103], a[208:211], v[16:19]
v_mfma_f32_16x16x32_bf16 v[20:23], v[100:103], a[212:215], v[20:23]
buffer_load_dwordx4 v[96:99], v4, s[16:19], s35 offen sc1
s_add_u32 s35, s35, 1024
v_mfma_f32_16x16x32_bf16 v[24:27], v[100:103], a[216:219], v[24:27]
v_mfma_f32_16x16x32_bf16 v[28:31], v[100:103], a[220:223], v[28:31]
s_waitcnt vmcnt(18)
v_mfma_f32_16x16x32_bf16 v[16:19], v[104:107], a[224:227], v[16:19]
v_mfma_f32_16x16x32_bf16 v[20:23], v[104:107], a[228:231], v[20:23]
buffer_load_dwordx4 v[100:103], v4, s[16:19], s35 offen sc1
s_add_u32 s35, s35, 1024
v_mfma_f32_16x16x32_bf16 v[24:27], v[104:107], a[232:235], v[24:27]
v_mfma_f32_16x16x32_bf16 v[28:31], v[104:107], a[236:239], v[28:31]
s_waitcnt vmcnt(18)
v_mfma_f32_16x16x32_bf16 v[16:19], v[108:111], a[240:243], v[16:19]
v_mfma_f32_16x16x32_bf16 v[20:23], v[108:111], a[244:247], v[20:23]
buffer_load_dwordx4 v[104:107], v4, s[16:19], s35 offen sc1
s_add_u32 s35, s35, 1024
v_mfma_f32_16x16x32_bf16 v[24:27], v[108:111], a[248:251], v[24:27]
v_mfma_f32_16x16x32_bf16 v[28:31], v[108:111], a[252:255], v[28:31]
s_waitcnt vmcnt(18)
v_mfma_f32_16x16x32_bf16 v[16:19], v[112:115], v[224:227], v[16:19]
v_mfma_f32_16x16x32_bf16 v[20:23], v[112:115], v[228:231], v[20:23]
buffer_load_dwordx4 v[108:111], v4, s[16:19], s35 offen sc1
s_add_u32 s35, s35, 1024
v_mfma_f32_16x16x32_bf16 v[24:27], v[112:115], v[232:235], v[24:27]
v_mfma_f32_16x16x32_bf16 v[28:31], v[112:115], v[236:239], v[28:31]
s_waitcnt vmcnt(18)
v_mfma_f32_16x16x32_bf16 v[16:19], v[116:119], v[240:243], v[16:19]
v_mfma_f32_16x16x32_bf16 v[20:23], v[116:119], v[244:247], v[20:23]
buffer_load_dwordx4 v[112:115], v4, s[16:19], s35 offen sc1
s_add_u32 s35, s35, 1024
v_mfma_f32_16x16x32_bf16 v[24:27], v[116:119], v[248:251], v[24:27]
v_mfma_f32_16x16x32_bf16 v[28:31], v[116:119], v[252:255], v[28:31]
s_cmp_eq_u32 s37, 1
s_cbranch_scc0 ffn_kernel_e2
v_mov_b32 v14, 0
v_mov_b32 v15, 1
s_mov_b64 s[50:51], exec
s_mov_b64 exec, 1
buffer_atomic_add v15, v14, s[52:55], s59 offen
s_mov_b64 exec, s[50:51]
ffn_kernel_e2:
s_sub_u32 s37, s37, 1
s_cmp_lg_u32 s37, 0
s_cbranch_scc1 ffn_kernel_l2
s_waitcnt vmcnt(18)
v_mfma_f32_16x16x32_bf16 v[48:51], v[144:147], a[0:3], 0
v_mfma_f32_16x16x32_bf16 v[52:55], v[144:147], a[4:7], 0
buffer_load_dwordx4 v[116:119], v4, s[16:19], s35 offen sc1
s_add_u32 s35, s35, 1024
v_mfma_f32_16x16x32_bf16 v[56:59], v[144:147], a[8:11], 0
v_mfma_f32_16x16x32_bf16 v[60:63], v[144:147], a[12:15], 0
s_waitcnt vmcnt(18)
v_mfma_f32_16x16x32_bf16 v[48:51], v[148:151], a[16:19], v[48:51]
v_mfma_f32_16x16x32_bf16 v[52:55], v[148:151], a[20:23], v[52:55]
buffer_load_dwordx4 v[144:147], v4, s[16:19], s35 offen sc1
s_add_u32 s35, s35, 1024
v_mfma_f32_16x16x32_bf16 v[56:59], v[148:151], a[24:27], v[56:59]
v_cvt_pk_bf16_f32 v88, v16, v17
v_mfma_f32_16x16x32_bf16 v[60:63], v[148:151], a[28:31], v[60:63]
v_cvt_pk_bf16_f32 v89, v18, v19
s_waitcnt vmcnt(18)
v_mfma_f32_16x16x32_bf16 v[48:51], v[152:155], a[32:35], v[48:51]
v_mfma_f32_16x16x32_bf16 v[52:55], v[152:155], a[36:39], v[52:55]
buffer_load_dwordx4 v[148:151], v4, s[16:19], s35 offen sc1
s_add_u32 s35, s35, 1024
v_mfma_f32_16x16x32_bf16 v[56:59], v[152:155], a[40:43], v[56:59]
v_cvt_pk_bf16_f32 v90, v20, v21
v_mfma_f32_16x16x32_bf16 v[60:63], v[152:155], a[44:47], v[60:63]
v_cvt_pk_bf16_f32 v91, v22, v23
s_waitcnt vmcnt(18)
v_mfma_f32_16x16x32_bf16 v[48:51], v[156:159], a[48:51], v[48:51]
v_mfma_f32_16x16x32_bf16 v[52:55], v[156:159], a[52:55], v[52:55]
buffer_load_dwordx4 v[152:155], v4, s[16:19], s35 offen sc1
s_add_u32 s35, s35, 1024
v_mfma_f32_16x16x32_bf16 v[56:59], v[156:159], a[56:59], v[56:59]
v_permlane16_swap_b32 v88, v90
v_mfma_f32_16x16x32_bf16 v[60:63], v[156:159], a[60:63], v[60:63]
v_permlane16_swap_b32 v89, v91
s_waitcnt vmcnt(17)
v_mfma_f32_16x16x32_bf16 v[48:51], v[160:163], a[64:67], v[48:51]
v_mfma_f32_16x16x32_bf16 v[52:55], v[160:163], a[68:71], v[52:55]
buffer_load_dwordx4 v[156:159], v4, s[16:19], s35 offen sc1
s_add_u32 s35, s35, 1024
v_mfma_f32_16x16x32_bf16 v[56:59], v[160:163], a[72:75], v[56:59]
buffer_store_dwordx4 v[88:91], v8, s[24:27], s36 offen sc1
v_mfma_f32_16x16x32_bf16 v[60:63], v[160:163], a[76:79], v[60:63]
ds_write_b128 v10, v[88:91]
s_waitcnt vmcnt(18)
v_mfma_f32_16x16x32_bf16 v[48:51], v[164:167], a[80:83], v[48:51]
v_mfma_f32_16x16x32_bf16 v[52:55], v[164:167], a[84:87], v[52:55]
buffer_load_dwordx4 v[160:163], v4, s[16:19], s35 offen sc1
s_add_u32 s35, s35, 1024
v_mfma_f32_16x16x32_bf16 v[56:59], v[164:167], a[88:91], v[56:59]
s_add_u32 s36, s36, 1024
v_mfma_f32_16x16x32_bf16 v[60:63], v[164:167], a[92:95], v[60:63]
v_add_u32 v10, 0x400, v10
s_waitcnt vmcnt(18)
v_mfma_f32_16x16x32_bf16 v[48:51], v[168:171], a[96:99], v[48:51]
v_mfma_f32_16x16x32_bf16 v[52:55], v[168:171], a[100:103], v[52:55]
buffer_load_dwordx4 v[164:167], v4, s[16:19], s35 offen sc1
s_add_u32 s35, s35, 1024
v_mfma_f32_16x16x32_bf16 v[56:59], v[168:171], a[104:107], v[56:59]
v_cvt_pk_bf16_f32 v92, v24, v25
v_mfma_f32_16x16x32_bf16 v[60:63], v[168:171], a[108:111], v[60:63]
v_cvt_pk_bf16_f32 v93, v26, v27
s_waitcnt vmcnt(18)
v_mfma_f32_16x16x32_bf16 v[48:51], v[172:175], a[112:115], v[48:51]
v_mfma_f32_16x16x32_bf16 v[52:55], v[172:175], a[116:119], v[52:55]
buffer_load_dwordx4 v[168:171], v4, s[16:19], s35 offen sc1
s_add_u32 s35, s35, 1024
v_mfma_f32_16x16x32_bf16 v[56:59], v[172:175], a[120:123], v[56:59]
v_cvt_pk_bf16_f32 v94, v28, v29
v_mfma_f32_16x16x32_bf16 v[60:63], v[172:175], a[124:127], v[60:63]
v_cvt_pk_bf16_f32 v95, v30, v31
s_waitcnt vmcnt(18)
v_mfma_f32_16x16x32_bf16 v[48:51], v[176:179], a[128:131], v[48:51]
v_mfma_f32_16x16x32_bf16 v[52:55], v[176:179], a[132:135], v[52:55]
buffer_load_dwordx4 v[172:175], v4, s[16:19], s35 offen sc1
s_add_u32 s35, s35, 1024
v_mfma_f32_16x16x32_bf16 v[56:59], v[176:179], a[136:139], v[56:59]
v_permlane16_swap_b32 v92, v94
v_mfma_f32_16x16x32_bf16 v[60:63], v[176:179], a[140:143], v[60:63]
v_permlane16_swap_b32 v93, v95
s_waitcnt vmcnt(17)
v_mfma_f32_16x16x32_bf16 v[48:51], v[180:183], a[144:147], v[48:51]
v_mfma_f32_16x16x32_bf16 v[52:55], v[180:183], a[148:151], v[52:55]
buffer_load_dwordx4 v[176:179], v4, s[16:19], s35 offen sc1
s_add_u32 s35, s35, 1024
v_mfma_f32_16x16x32_bf16 v[56:59], v[180:183], a[152:155], v[56:59]
buffer_store_dwordx4 v[92:95], v9, s[24:27], s40 offen sc1
v_mfma_f32_16x16x32_bf16 v[60:63], v[180:183], a[156:159], v[60:63]
ds_write_b128 v11, v[92:95]
s_waitcnt vmcnt(18)
v_mfma_f32_16x16x32_bf16 v[48:51], v[184:187], a[160:163], v[48:51]
v_mfma_f32_16x16x32_bf16 v[52:55], v[184:187], a[164:167], v[52:55]
buffer_load_dwordx4 v[180:183], v4, s[16:19], s35 offen sc1
s_add_u32 s35, s35, 1024
v_mfma_f32_16x16x32_bf16 v[56:59], v[184:187], a[168:171], v[56:59]
s_add_u32 s40, s40, 1024
v_mfma_f32_16x16x32_bf16 v[60:63], v[184:187], a[172:175], v[60:63]
v_add_u32 v11, 0x400, v11
s_waitcnt vmcnt(18)
v_mfma_f32_16x16x32_bf16 v[48:51], v[188:191], a[176:179], v[48:51]
v_mfma_f32_16x16x32_bf16 v[52:55], v[188:191], a[180:183], v[52:55]
buffer_load_dwordx4 v[184:187], v4, s[16:19], s35 offen sc1
s_add_u32 s35, s35, 1024
v_mfma_f32_16x16x32_bf16 v[56:59], v[188:191], a[184:187], v[56:59]
v_mfma_f32_16x16x32_bf16 v[60:63], v[188:191], a[188:191], v[60:63]
s_waitcnt vmcnt(18)
v_mfma_f32_16x16x32_bf16 v[48:51], v[96:99], a[192:195], v[48:51]
v_mfma_f32_16x16x32_bf16 v[52:55], v[96:99], a[196:199], v[52:55]
buffer_load_dwordx4 v[188:191], v4, s[16:19], s35 offen sc1
s_add_u32 s35, s35, 1024
v_mfma_f32_16x16x32_bf16 v[56:59], v[96:99], a[200:203], v[56:59]
v_mfma_f32_16x16x32_bf16 v[60:63], v[96:99], a[204:207], v[60:63]
s_waitcnt vmcnt(18)
v_mfma_f32_16x16x32_bf16 v[48:51], v[100:103], a[208:211], v[48:51]
v_mfma_f32_16x16x32_bf16 v[52:55], v[100:103], a[212:215], v[52:55]
buffer_load_dwordx4 v[96:99], v4, s[16:19], s35 offen sc1
s_add_u32 s35, s35, 1024
v_mfma_f32_16x16x32_bf16 v[56:59], v[100:103], a[216:219], v[56:59]
v_mfma_f32_16x16x32_bf16 v[60:63], v[100:103], a[220:223], v[60:63]
s_waitcnt vmcnt(18)
v_mfma_f32_16x16x32_bf16 v[48:51], v[104:107], a[224:227], v[48:51]
v_mfma_f32_16x16x32_bf16 v[52:55], v[104:107], a[228:231], v[52:55]
buffer_load_dwordx4 v[100:103], v4, s[16:19], s35 offen sc1
s_add_u32 s35, s35, 1024
v_mfma_f32_16x16x32_bf16 v[56:59], v[104:107], a[232:235], v[56:59]
v_mfma_f32_16x16x32_bf16 v[60:63], v[104:107], a[236:239], v[60:63]
s_waitcnt vmcnt(18)
v_mfma_f32_16x16x32_bf16 v[48:51], v[108:111], a[240:243], v[48:51]
v_mfma_f32_16x16x32_bf16 v[52:55], v[108:111], a[244:247], v[52:55]
buffer_load_dwordx4 v[104:107], v4, s[16:19], s35 offen sc1
s_add_u32 s35, s35, 1024
v_mfma_f32_16x16x32_bf16 v[56:59], v[108:111], a[248:251], v[56:59]
v_mfma_f32_16x16x32_bf16 v[60:63], v[108:111], a[252:255], v[60:63]
s_waitcnt vmcnt(18)
v_mfma_f32_16x16x32_bf16 v[48:51], v[112:115], v[224:227], v[48:51]
v_mfma_f32_16x16x32_bf16 v[52:55], v[112:115], v[228:231], v[52:55]
buffer_load_dwordx4 v[108:111], v4, s[16:19], s35 offen sc1
s_add_u32 s35, s35, 1024
v_mfma_f32_16x16x32_bf16 v[56:59], v[112:115], v[232:235], v[56:59]
v_mfma_f32_16x16x32_bf16 v[60:63], v[112:115], v[236:239], v[60:63]
s_waitcnt vmcnt(18)
v_mfma_f32_16x16x32_bf16 v[48:51], v[116:119], v[240:243], v[48:51]
v_mfma_f32_16x16x32_bf16 v[52:55], v[116:119], v[244:247], v[52:55]
buffer_load_dwordx4 v[112:115], v4, s[16:19], s35 offen sc1
s_add_u32 s35, s35, 1024
v_mfma_f32_16x16x32_bf16 v[56:59], v[116:119], v[248:251], v[56:59]
v_mfma_f32_16x16x32_bf16 v[60:63], v[116:119], v[252:255], v[60:63]
s_waitcnt vmcnt(18)
v_mfma_f32_16x16x32_bf16 v[16:19], v[144:147], a[0:3], 0
v_mfma_f32_16x16x32_bf16 v[20:23], v[144:147], a[4:7], 0
buffer_load_dwordx4 v[116:119], v4, s[16:19], s35 offen sc1
s_add_u32 s35, s35, 1024
v_mfma_f32_16x16x32_bf16 v[24:27], v[144:147], a[8:11], 0
s_load_dword s83, s[84:85], 0
v_mfma_f32_16x16x32_bf16 v[28:31], v[144:147], a[12:15], 0
s_waitcnt vmcnt(18)
v_mfma_f32_16x16x32_bf16 v[16:19], v[148:151], a[16:19], v[16:19]
v_mfma_f32_16x16x32_bf16 v[20:23], v[148:151], a[20:23], v[20:23]
v_mfma_f32_16x16x32_bf16 v[24:27], v[148:151], a[24:27], v[24:27]
v_cvt_pk_bf16_f32 v88, v48, v49
v_mfma_f32_16x16x32_bf16 v[28:31], v[148:151], a[28:31], v[28:31]
v_cvt_pk_bf16_f32 v89, v50, v51
s_waitcnt vmcnt(17)
v_mfma_f32_16x16x32_bf16 v[16:19], v[152:155], a[32:35], v[16:19]
v_mfma_f32_16x16x32_bf16 v[20:23], v[152:155], a[36:39], v[20:23]
v_mfma_f32_16x16x32_bf16 v[24:27], v[152:155], a[40:43], v[24:27]
v_cvt_pk_bf16_f32 v90, v52, v53
v_mfma_f32_16x16x32_bf16 v[28:31], v[152:155], a[44:47], v[28:31]
v_cvt_pk_bf16_f32 v91, v54, v55
s_waitcnt vmcnt(16)
v_mfma_f32_16x16x32_bf16 v[16:19], v[156:159], a[48:51], v[16:19]
v_mfma_f32_16x16x32_bf16 v[20:23], v[156:159], a[52:55], v[20:23]
v_mfma_f32_16x16x32_bf16 v[24:27], v[156:159], a[56:59], v[24:27]
v_permlane16_swap_b32 v88, v90
v_mfma_f32_16x16x32_bf16 v[28:31], v[156:159], a[60:63], v[28:31]
v_permlane16_swap_b32 v89, v91
s_waitcnt vmcnt(14)
v_mfma_f32_16x16x32_bf16 v[16:19], v[160:163], a[64:67], v[16:19]
v_mfma_f32_16x16x32_bf16 v[20:23], v[160:163], a[68:71], v[20:23]
v_mfma_f32_16x16x32_bf16 v[24:27], v[160:163], a[72:75], v[24:27]
buffer_store_dwordx4 v[88:91], v8, s[24:27], s36 offen sc1
v_mfma_f32_16x16x32_bf16 v[28:31], v[160:163], a[76:79], v[28:31]
ds_write_b128 v10, v[88:91]
s_waitcnt vmcnt(14)
v_mfma_f32_16x16x32_bf16 v[16:19], v[164:167], a[80:83], v[16:19]
v_mfma_f32_16x16x32_bf16 v[20:23], v[164:167], a[84:87], v[20:23]
v_mfma_f32_16x16x32_bf16 v[24:27], v[164:167], a[88:91], v[24:27]
s_add_u32 s36, s36, 1024
v_mfma_f32_16x16x32_bf16 v[28:31], v[164:167], a[92:95], v[28:31]
v_add_u32 v10, 0x400, v10
s_waitcnt vmcnt(13)
s_waitcnt lgkmcnt(0)
s_cmp_eq_u32 s83, 32
s_cbranch_scc0 ffn_kernel_e3
s_mov_b32 s33, 1
s_cmp_eq_u32 s30, 0
s_cselect_b32 s48, 0x70000000, s80
buffer_load_dwordx4 v[120:123], v4, s[24:27], s48 offen sc1
s_add_u32 s80, s80, 9216
s_cmp_eq_u32 s30, 1
s_cselect_b32 s48, 0x70000000, s80
buffer_load_dwordx4 v[124:127], v4, s[24:27], s48 offen sc1
s_add_u32 s80, s80, 9216
s_cmp_eq_u32 s30, 2
s_cselect_b32 s48, 0x70000000, s80
buffer_load_dwordx4 v[128:131], v4, s[24:27], s48 offen sc1
s_add_u32 s80, s80, 9216
s_cmp_eq_u32 s30, 3
s_cselect_b32 s48, 0x70000000, s80
buffer_load_dwordx4 v[132:135], v4, s[24:27], s48 offen sc1
s_add_u32 s80, s80, 9216
s_cmp_eq_u32 s30, 4
s_cselect_b32 s48, 0x70000000, s80
buffer_load_dwordx4 v[136:139], v4, s[24:27], s48 offen sc1
s_add_u32 s80, s80, 9216
s_cmp_eq_u32 s30, 5
s_cselect_b32 s48, 0x70000000, s80
buffer_load_dwordx4 v[140:143], v4, s[24:27], s48 offen sc1
s_add_u32 s80, s80, 9216
s_cmp_eq_u32 s30, 6
s_cselect_b32 s48, 0x70000000, s80
buffer_load_dwordx4 v[204:207], v4, s[24:27], s48 offen sc1
s_add_u32 s80, s80, 9216
s_cmp_eq_u32 s30, 7
s_cselect_b32 s48, 0x70000000, s80
buffer_load_dwordx4 v[208:211], v4, s[24:27], s48 offen sc1
ffn_kernel_e3:
v_mfma_f32_16x16x32_bf16 v[16:19], v[168:171], a[96:99], v[16:19]
v_mfma_f32_16x16x32_bf16 v[20:23], v[168:171], a[100:103], v[20:23]
v_mfma_f32_16x16x32_bf16 v[24:27], v[168:171], a[104:107], v[24:27]
v_cvt_pk_bf16_f32 v92, v56, v57
v_mfma_f32_16x16x32_bf16 v[28:31], v[168:171], a[108:111], v[28:31]
v_cvt_pk_bf16_f32 v93, v58, v59
s_waitcnt vmcnt(12)
v_mfma_f32_16x16x32_bf16 v[16:19], v[172:175], a[112:115], v[16:19]
v_mfma_f32_16x16x32_bf16 v[20:23], v[172:175], a[116:119], v[20:23]
v_mfma_f32_16x16x32_bf16 v[24:27], v[172:175], a[120:123], v[24:27]
v_cvt_pk_bf16_f32 v94, v60, v61
v_mfma_f32_16x16x32_bf16 v[28:31], v[172:175], a[124:127], v[28:31]
v_cvt_pk_bf16_f32 v95, v62, v63
s_waitcnt vmcnt(11)
v_mfma_f32_16x16x32_bf16 v[16:19], v[176:179], a[128:131], v[16:19]
v_mfma_f32_16x16x32_bf16 v[20:23], v[176:179], a[132:135], v[20:23]
v_mfma_f32_16x16x32_bf16 v[24:27], v[176:179], a[136:139], v[24:27]
v_permlane16_swap_b32 v92, v94
v_mfma_f32_16x16x32_bf16 v[28:31], v[176:179], a[140:143], v[28:31]
v_permlane16_swap_b32 v93, v95
s_waitcnt vmcnt(9)
v_mfma_f32_16x16x32_bf16 v[16:19], v[180:183], a[144:147], v[16:19]
v_mfma_f32_16x16x32_bf16 v[20:23], v[180:183], a[148:151], v[20:23]
v_mfma_f32_16x16x32_bf16 v[24:27], v[180:183], a[152:155], v[24:27]
buffer_store_dwordx4 v[92:95], v9, s[24:27], s40 offen sc1
v_mfma_f32_16x16x32_bf16 v[28:31], v[180:183], a[156:159], v[28:31]
ds_write_b128 v11, v[92:95]
s_waitcnt vmcnt(9)
v_mfma_f32_16x16x32_bf16 v[16:19], v[184:187], a[160:163], v[16:19]
v_mfma_f32_16x16x32_bf16 v[20:23], v[184:187], a[164:167], v[20:23]
v_mfma_f32_16x16x32_bf16 v[24:27], v[184:187], a[168:171], v[24:27]
s_add_u32 s40, s40, 1024
v_mfma_f32_16x16x32_bf16 v[28:31], v[184:187], a[172:175], v[28:31]
v_add_u32 v11, 0x400, v11
s_waitcnt vmcnt(8)
v_mfma_f32_16x16x32_bf16 v[16:19], v[188:191], a[176:179], v[16:19]
v_mfma_f32_16x16x32_bf16 v[20:23], v[188:191], a[180:183], v[20:23]
v_mfma_f32_16x16x32_bf16 v[24:27], v[188:191], a[184:187], v[24:27]
v_mfma_f32_16x16x32_bf16 v[28:31], v[188:191], a[188:191], v[28:31]
s_waitcnt vmcnt(7)
v_mfma_f32_16x16x32_bf16 v[16:19], v[96:99], a[192:195], v[16:19]
v_mfma_f32_16x16x32_bf16 v[20:23], v[96:99], a[196:199], v[20:23]
v_mfma_f32_16x16x32_bf16 v[24:27], v[96:99], a[200:203], v[24:27]
v_mfma_f32_16x16x32_bf16 v[28:31], v[96:99], a[204:207], v[28:31]
s_waitcnt vmcnt(6)
v_mfma_f32_16x16x32_bf16 v[16:19], v[100:103], a[208:211], v[16:19]
v_mfma_f32_16x16x32_bf16 v[20:23], v[100:103], a[212:215], v[20:23]
v_mfma_f32_16x16x32_bf16 v[24:27], v[100:103], a[216:219], v[24:27]
v_mfma_f32_16x16x32_bf16 v[28:31], v[100:103], a[220:223], v[28:31]
s_waitcnt vmcnt(5)
v_mfma_f32_16x16x32_bf16 v[16:19], v[104:107], a[224:227], v[16:19]
v_mfma_f32_16x16x32_bf16 v[20:23], v[104:107], a[228:231], v[20:23]
v_mfma_f32_16x16x32_bf16 v[24:27], v[104:107], a[232:235], v[24:27]
v_mfma_f32_16x16x32_bf16 v[28:31], v[104:107], a[236:239], v[28:31]
s_waitcnt vmcnt(4)
v_mfma_f32_16x16x32_bf16 v[16:19], v[108:111], a[240:243], v[16:19]
v_mfma_f32_16x16x32_bf16 v[20:23], v[108:111], a[244:247], v[20:23]
v_mfma_f32_16x16x32_bf16 v[24:27], v[108:111], a[248:251], v[24:27]
v_mfma_f32_16x16x32_bf16 v[28:31], v[108:111], a[252:255], v[28:31]
s_waitcnt vmcnt(3)
v_mfma_f32_16x16x32_bf16 v[16:19], v[112:115], v[224:227], v[16:19]
v_mfma_f32_16x16x32_bf16 v[20:23], v[112:115], v[228:231], v[20:23]
v_mfma_f32_16x16x32_bf16 v[24:27], v[112:115], v[232:235], v[24:27]
v_mfma_f32_16x16x32_bf16 v[28:31], v[112:115], v[236:239], v[28:31]
s_waitcnt vmcnt(2)
v_mfma_f32_16x16x32_bf16 v[16:19], v[116:119], v[240:243], v[16:19]
v_mfma_f32_16x16x32_bf16 v[20:23], v[116:119], v[244:247], v[20:23]
v_mfma_f32_16x16x32_bf16 v[24:27], v[116:119], v[248:251], v[24:27]
v_mfma_f32_16x16x32_bf16 v[28:31], v[116:119], v[252:255], v[28:31]
s_nop 7
v_cvt_pk_bf16_f32 v88, v16, v17
v_cvt_pk_bf16_f32 v89, v18, v19
v_cvt_pk_bf16_f32 v90, v20, v21
v_cvt_pk_bf16_f32 v91, v22, v23
s_nop 1
v_permlane16_swap_b32 v88, v90
v_permlane16_swap_b32 v89, v91
buffer_store_dwordx4 v[88:91], v8, s[24:27], s36 offen sc1
ds_write_b128 v10, v[88:91]
s_add_u32 s36, s36, 1024
v_add_u32 v10, 0x400, v10
v_cvt_pk_bf16_f32 v92, v24, v25
v_cvt_pk_bf16_f32 v93, v26, v27
v_cvt_pk_bf16_f32 v94, v28, v29
v_cvt_pk_bf16_f32 v95, v30, v31
s_nop 1
v_permlane16_swap_b32 v92, v94
v_permlane16_swap_b32 v93, v95
buffer_store_dwordx4 v[92:95], v9, s[24:27], s40 offen sc1
ds_write_b128 v11, v[92:95]
s_add_u32 s40, s40, 1024
v_add_u32 v11, 0x400, v11
s_load_dwordx2 s[42:43], s[0:1], 96
v_and_b32 v2, 7, v1
v_lshrrev_b32 v3, 3, v1
v_mul_u32_u24 v212, 1152, v2
v_lshl_add_u32 v212, v3, 4, v212
v_lshlrev_b32 v213, 5, v3
s_mov_b32 s49, 11520
s_add_u32 s48, s28, 0
s_mul_i32 s77, s48, 256
s_add_u32 s77, s77, s49
s_cmp_lt_u32 s48, 9
s_cselect_b32 s77, s77, 0x70000000
s_add_u32 s48, s28, 4
s_mul_i32 s78, s48, 256
s_add_u32 s78, s78, s49
s_cmp_lt_u32 s48, 9
s_cselect_b32 s78, s78, 0x70000000
s_add_u32 s48, s28, 8
s_mul_i32 s79, s48, 256
s_add_u32 s79, s79, s49
s_cmp_lt_u32 s48, 9
s_cselect_b32 s79, s79, 0x70000000
s_waitcnt vmcnt(0) lgkmcnt(0)
s_barrier
s_cmp_lg_u32 s28, 0
s_cbranch_scc1 ffn_kernel_f2_set
s_lshl_b32 s49, s29, 7
s_lshl_b32 s48, s30, 2
s_add_u32 s49, s49, s48
s_add_u32 s49, s49, 4096
v_mov_b32 v14, 0
v_mov_b32 v15, 1
s_mov_b64 s[50:51], exec
s_mov_b64 exec, 1
buffer_store_dword v15, v14, s[52:55], s49 offen sc1
s_mov_b64 exec, s[50:51]
ffn_kernel_f2_set:
buffer_load_dwordx4 v[16:19], v213, s[68:71], s77 offen offset:0
buffer_load_dwordx4 v[20:23], v213, s[68:71], s77 offen offset:16
buffer_load_dwordx4 v[24:27], v213, s[68:71], s78 offen offset:0
buffer_load_dwordx4 v[28:31], v213, s[68:71], s78 offen offset:16
buffer_load_dwordx4 v[32:35], v213, s[68:71], s79 offen offset:0
buffer_load_dwordx4 v[36:39], v213, s[68:71], s79 offen offset:16
s_add_u32 s60, s42, 0
s_addc_u32 s61, s43, 0
s_and_b32 s61, s61, 0xffff
s_mov_b32 s62, 2359296
s_mov_b32 s63, 0x00020000
s_lshl_b32 s48, s28, 10
s_add_u32 s48, s48, 73728
v_add_u32 v214, s48, v4
ds_read_b128 v[64:67], v214 offset:0
ds_read_b128 v[68:71], v214 offset:4096
ds_read_b128 v[72:75], v214 offset:8192
s_cmp_lg_u32 s28, 0
s_cbranch_scc1 ffn_kernel_w2_ok
s_mov_b32 s48, 20000
s_lshl_b32 s49, s29, 7
v_lshlrev_b32 v12, 2, v1
s_add_u32 s49, s49, 4096
v_mov_b32 v13, 0x7f000000
v_cmp_gt_u32 vcc, 8, v1
s_nop 1
v_cndmask_b32 v12, v13, v12, vcc
s_mov_b32 s50, 0xff
s_mov_b32 s51, 0
ffn_kernel_w2_poll:
buffer_load_dword v13, v12, s[52:55], s49 offen sc1
s_waitcnt vmcnt(0)
v_cmp_eq_u32 vcc, 1, v13
s_nop 3
s_cmp_eq_u64 vcc, s[50:51]
s_cbranch_scc1 ffn_kernel_w2_ok
s_sub_u32 s48, s48, 1
s_cmp_eq_u32 s48, 0
s_cbranch_scc1 ffn_kernel_w2_ok
s_sleep 2
s_branch ffn_kernel_w2_poll
ffn_kernel_w2_ok:
s_barrier
s_cmp_eq_u32 s30, 0
s_cselect_b32 s48, 0x70000000, s81
buffer_load_dwordx4 v[144:147], v4, s[24:27], s48 offen sc1
s_add_u32 s81, s81, 9216
s_cmp_eq_u32 s30, 1
s_cselect_b32 s48, 0x70000000, s81
buffer_load_dwordx4 v[148:151], v4, s[24:27], s48 offen sc1
s_add_u32 s81, s81, 9216
s_cmp_eq_u32 s30, 2
s_cselect_b32 s48, 0x70000000, s81
buffer_load_dwordx4 v[152:155], v4, s[24:27], s48 offen sc1
s_add_u32 s81, s81, 9216
s_cmp_eq_u32 s30, 3
s_cselect_b32 s48, 0x70000000, s81
buffer_load_dwordx4 v[156:159], v4, s[24:27], s48 offen sc1
s_add_u32 s81, s81, 9216
s_cmp_eq_u32 s30, 4
s_cselect_b32 s48, 0x70000000, s81
buffer_load_dwordx4 v[160:163], v4, s[24:27], s48 offen sc1
s_add_u32 s81, s81, 9216
s_cmp_eq_u32 s30, 5
s_cselect_b32 s48, 0x70000000, s81
buffer_load_dwordx4 v[164:167], v4, s[24:27], s48 offen sc1
s_add_u32 s81, s81, 9216
s_cmp_eq_u32 s30, 6
s_cselect_b32 s48, 0x70000000, s81
buffer_load_dwordx4 v[168:171], v4, s[24:27], s48 offen sc1
s_add_u32 s81, s81, 9216
s_cmp_eq_u32 s30, 7
s_cselect_b32 s48, 0x70000000, s81
buffer_load_dwordx4 v[172:175], v4, s[24:27], s48 offen sc1
s_cmp_eq_u32 s30, 0
s_cselect_b32 s48, 0x70000000, s82
buffer_load_dwordx4 v[96:99], v4, s[24:27], s48 offen sc1
s_add_u32 s82, s82, 9216
s_cmp_eq_u32 s30, 1
s_cselect_b32 s48, 0x70000000, s82
buffer_load_dwordx4 v[100:103], v4, s[24:27], s48 offen sc1
s_add_u32 s82, s82, 9216
s_cmp_eq_u32 s30, 2
s_cselect_b32 s48, 0x70000000, s82
buffer_load_dwordx4 v[104:107], v4, s[24:27], s48 offen sc1
s_add_u32 s82, s82, 9216
s_cmp_eq_u32 s30, 3
s_cselect_b32 s48, 0x70000000, s82
buffer_load_dwordx4 v[108:111], v4, s[24:27], s48 offen sc1
s_add_u32 s82, s82, 9216
s_cmp_eq_u32 s30, 4
s_cselect_b32 s48, 0x70000000, s82
buffer_load_dwordx4 v[112:115], v4, s[24:27], s48 offen sc1
s_add_u32 s82, s82, 9216
s_cmp_eq_u32 s30, 5
s_cselect_b32 s48, 0x70000000, s82
buffer_load_dwordx4 v[116:119], v4, s[24:27], s48 offen sc1
s_add_u32 s82, s82, 9216
s_cmp_eq_u32 s30, 6
s_cselect_b32 s48, 0x70000000, s82
buffer_load_dwordx4 v[176:179], v4, s[24:27], s48 offen sc1
s_add_u32 s82, s82, 9216
s_cmp_eq_u32 s30, 7
s_cselect_b32 s48, 0x70000000, s82
buffer_load_dwordx4 v[180:183], v4, s[24:27], s48 offen sc1
s_cmp_eq_u32 s33, 1
s_cbranch_scc1 ffn_kernel_early0
s_cmp_eq_u32 s30, 0
s_cselect_b32 s48, 0x70000000, s80
buffer_load_dwordx4 v[120:123], v4, s[24:27], s48 offen sc1
s_add_u32 s80, s80, 9216
s_cmp_eq_u32 s30, 1
s_cselect_b32 s48, 0x70000000, s80
buffer_load_dwordx4 v[124:127], v4, s[24:27], s48 offen sc1
s_add_u32 s80, s80, 9216
s_cmp_eq_u32 s30, 2
s_cselect_b32 s48, 0x70000000, s80
buffer_load_dwordx4 v[128:131], v4, s[24:27], s48 offen sc1
s_add_u32 s80, s80, 9216
s_cmp_eq_u32 s30, 3
s_cselect_b32 s48, 0x70000000, s80
buffer_load_dwordx4 v[132:135], v4, s[24:27], s48 offen sc1
s_add_u32 s80, s80, 9216
s_cmp_eq_u32 s30, 4
s_cselect_b32 s48, 0x70000000, s80
buffer_load_dwordx4 v[136:139], v4, s[24:27], s48 offen sc1
s_add_u32 s80, s80, 9216
s_cmp_eq_u32 s30, 5
s_cselect_b32 s48, 0x70000000, s80
buffer_load_dwordx4 v[140:143], v4, s[24:27], s48 offen sc1
s_add_u32 s80, s80, 9216
s_cmp_eq_u32 s30, 6
s_cselect_b32 s48, 0x70000000, s80
buffer_load_dwordx4 v[204:207], v4, s[24:27], s48 offen sc1
s_add_u32 s80, s80, 9216
s_cmp_eq_u32 s30, 7
s_cselect_b32 s48, 0x70000000, s80
buffer_load_dwordx4 v[208:211], v4, s[24:27], s48 offen sc1
s_waitcnt vmcnt(0)
ffn_kernel_early0:
s_waitcnt vmcnt(16) lgkmcnt(0)
v_lshlrev_b32 v40, 16, v120
v_and_b32 v41, 0xffff0000, v120
v_lshlrev_b32 v42, 16, v121
v_and_b32 v43, 0xffff0000, v121
v_lshlrev_b32 v44, 16, v122
v_and_b32 v45, 0xffff0000, v122
v_lshlrev_b32 v46, 16, v123
v_and_b32 v47, 0xffff0000, v123
v_lshlrev_b32 v48, 16, v124
v_and_b32 v49, 0xffff0000, v124
v_pk_add_f32 v[40:41], v[40:41], v[48:49]
v_lshlrev_b32 v50, 16, v125
v_and_b32 v51, 0xffff0000, v125
v_pk_add_f32 v[42:43], v[42:43], v[50:51]
v_lshlrev_b32 v48, 16, v126
v_and_b32 v49, 0xffff0000, v126
v_pk_add_f32 v[44:45], v[44:45], v[48:49]
v_lshlrev_b32 v50, 16, v127
v_and_b32 v51, 0xffff0000, v127
v_pk_add_f32 v[46:47], v[46:47], v[50:51]
v_lshlrev_b32 v48, 16, v128
v_and_b32 v49, 0xffff0000, v128
v_pk_add_f32 v[40:41], v[40:41], v[48:49]
v_lshlrev_b32 v50, 16, v129
v_and_b32 v51, 0xffff0000, v129
v_pk_add_f32 v[42:43], v[42:43], v[50:51]
v_lshlrev_b32 v48, 16, v130
v_and_b32 v49, 0xffff0000, v130
v_pk_add_f32 v[44:45], v[44:45], v[48:49]
v_lshlrev_b32 v50, 16, v131
v_and_b32 v51, 0xffff0000, v131
v_pk_add_f32 v[46:47], v[46:47], v[50:51]
v_lshlrev_b32 v48, 16, v132
v_and_b32 v49, 0xffff0000, v132
v_pk_add_f32 v[40:41], v[40:41], v[48:49]
v_lshlrev_b32 v50, 16, v133
v_and_b32 v51, 0xffff0000, v133
v_pk_add_f32 v[42:43], v[42:43], v[50:51]
v_lshlrev_b32 v48, 16, v134
v_and_b32 v49, 0xffff0000, v134
v_pk_add_f32 v[44:45], v[44:45], v[48:49]
v_lshlrev_b32 v50, 16, v135
v_and_b32 v51, 0xffff0000, v135
v_pk_add_f32 v[46:47], v[46:47], v[50:51]
v_lshlrev_b32 v48, 16, v136
v_and_b32 v49, 0xffff0000, v136
v_pk_add_f32 v[40:41], v[40:41], v[48:49]
v_lshlrev_b32 v50, 16, v137
v_and_b32 v51, 0xffff0000, v137
v_pk_add_f32 v[42:43], v[42:43], v[50:51]
v_lshlrev_b32 v48, 16, v138
v_and_b32 v49, 0xffff0000, v138
v_pk_add_f32 v[44:45], v[44:45], v[48:49]
v_lshlrev_b32 v50, 16, v139
v_and_b32 v51, 0xffff0000, v139
v_pk_add_f32 v[46:47], v[46:47], v[50:51]
v_lshlrev_b32 v48, 16, v140
v_and_b32 v49, 0xffff0000, v140
v_pk_add_f32 v[40:41], v[40:41], v[48:49]
v_lshlrev_b32 v50, 16, v141
v_and_b32 v51, 0xffff0000, v141
v_pk_add_f32 v[42:43], v[42:43], v[50:51]
v_lshlrev_b32 v48, 16, v142
v_and_b32 v49, 0xffff0000, v142
v_pk_add_f32 v[44:45], v[44:45], v[48:49]
v_lshlrev_b32 v50, 16, v143
v_and_b32 v51, 0xffff0000, v143
v_pk_add_f32 v[46:47], v[46:47], v[50:51]
v_lshlrev_b32 v48, 16, v204
v_and_b32 v49, 0xffff0000, v204
v_pk_add_f32 v[40:41], v[40:41], v[48:49]
v_lshlrev_b32 v50, 16, v205
v_and_b32 v51, 0xffff0000, v205
v_pk_add_f32 v[42:43], v[42:43], v[50:51]
v_lshlrev_b32 v48, 16, v206
v_and_b32 v49, 0xffff0000, v206
v_pk_add_f32 v[44:45], v[44:45], v[48:49]
v_lshlrev_b32 v50, 16, v207
v_and_b32 v51, 0xffff0000, v207
v_pk_add_f32 v[46:47], v[46:47], v[50:51]
v_lshlrev_b32 v48, 16, v208
v_and_b32 v49, 0xffff0000, v208
v_pk_add_f32 v[40:41], v[40:41], v[48:49]
v_lshlrev_b32 v50, 16, v209
v_and_b32 v51, 0xffff0000, v209
v_pk_add_f32 v[42:43], v[42:43], v[50:51]
v_lshlrev_b32 v48, 16, v210
v_and_b32 v49, 0xffff0000, v210
v_pk_add_f32 v[44:45], v[44:45], v[48:49]
v_lshlrev_b32 v50, 16, v211
v_and_b32 v51, 0xffff0000, v211
v_pk_add_f32 v[46:47], v[46:47], v[50:51]
v_lshlrev_b32 v48, 16, v64
v_and_b32 v49, 0xffff0000, v64
v_pk_add_f32 v[40:41], v[40:41], v[48:49]
v_lshlrev_b32 v50, 16, v65
v_and_b32 v51, 0xffff0000, v65
v_pk_add_f32 v[42:43], v[42:43], v[50:51]
v_lshlrev_b32 v48, 16, v66
v_and_b32 v49, 0xffff0000, v66
v_pk_add_f32 v[44:45], v[44:45], v[48:49]
v_lshlrev_b32 v50, 16, v67
v_and_b32 v51, 0xffff0000, v67
v_pk_add_f32 v[46:47], v[46:47], v[50:51]
v_lshlrev_b32 v48, 16, v192
v_and_b32 v49, 0xffff0000, v192
v_pk_fma_f32 v[40:41], v[40:41], v[16:17], v[48:49]
v_lshlrev_b32 v50, 16, v193
v_and_b32 v51, 0xffff0000, v193
v_pk_fma_f32 v[42:43], v[42:43], v[18:19], v[50:51]
v_lshlrev_b32 v48, 16, v194
v_and_b32 v49, 0xffff0000, v194
v_pk_fma_f32 v[44:45], v[44:45], v[20:21], v[48:49]
v_lshlrev_b32 v50, 16, v195
v_and_b32 v51, 0xffff0000, v195
v_pk_fma_f32 v[46:47], v[46:47], v[22:23], v[50:51]
v_cvt_pk_bf16_f32 v52, v40, v41
v_cvt_pk_bf16_f32 v53, v42, v43
v_cvt_pk_bf16_f32 v54, v44, v45
v_cvt_pk_bf16_f32 v55, v46, v47
buffer_store_dwordx4 v[52:55], v212, s[60:63], s72 offen
s_waitcnt vmcnt(16)
v_lshlrev_b32 v40, 16, v144
v_and_b32 v41, 0xffff0000, v144
v_lshlrev_b32 v42, 16, v145
v_and_b32 v43, 0xffff0000, v145
v_lshlrev_b32 v44, 16, v146
v_and_b32 v45, 0xffff0000, v146
v_lshlrev_b32 v46, 16, v147
v_and_b32 v47, 0xffff0000, v147
s_waitcnt vmcnt(15)
v_lshlrev_b32 v48, 16, v148
v_and_b32 v49, 0xffff0000, v148
v_pk_add_f32 v[40:41], v[40:41], v[48:49]
v_lshlrev_b32 v50, 16, v149
v_and_b32 v51, 0xffff0000, v149
v_pk_add_f32 v[42:43], v[42:43], v[50:51]
v_lshlrev_b32 v48, 16, v150
v_and_b32 v49, 0xffff0000, v150
v_pk_add_f32 v[44:45], v[44:45], v[48:49]
v_lshlrev_b32 v50, 16, v151
v_and_b32 v51, 0xffff0000, v151
v_pk_add_f32 v[46:47], v[46:47], v[50:51]
s_waitcnt vmcnt(14)
v_lshlrev_b32 v48, 16, v152
v_and_b32 v49, 0xffff0000, v152
v_pk_add_f32 v[40:41], v[40:41], v[48:49]
v_lshlrev_b32 v50, 16, v153
v_and_b32 v51, 0xffff0000, v153
v_pk_add_f32 v[42:43], v[42:43], v[50:51]
v_lshlrev_b32 v48, 16, v154
v_and_b32 v49, 0xffff0000, v154
v_pk_add_f32 v[44:45], v[44:45], v[48:49]
v_lshlrev_b32 v50, 16, v155
v_and_b32 v51, 0xffff0000, v155
v_pk_add_f32 v[46:47], v[46:47], v[50:51]
s_waitcnt vmcnt(13)
v_lshlrev_b32 v48, 16, v156
v_and_b32 v49, 0xffff0000, v156
v_pk_add_f32 v[40:41], v[40:41], v[48:49]
v_lshlrev_b32 v50, 16, v157
v_and_b32 v51, 0xffff0000, v157
v_pk_add_f32 v[42:43], v[42:43], v[50:51]
v_lshlrev_b32 v48, 16, v158
v_and_b32 v49, 0xffff0000, v158
v_pk_add_f32 v[44:45], v[44:45], v[48:49]
v_lshlrev_b32 v50, 16, v159
v_and_b32 v51, 0xffff0000, v159
v_pk_add_f32 v[46:47], v[46:47], v[50:51]
s_waitcnt vmcnt(12)
v_lshlrev_b32 v48, 16, v160
v_and_b32 v49, 0xffff0000, v160
v_pk_add_f32 v[40:41], v[40:41], v[48:49]
v_lshlrev_b32 v50, 16, v161
v_and_b32 v51, 0xffff0000, v161
v_pk_add_f32 v[42:43], v[42:43], v[50:51]
v_lshlrev_b32 v48, 16, v162
v_and_b32 v49, 0xffff0000, v162
v_pk_add_f32 v[44:45], v[44:45], v[48:49]
v_lshlrev_b32 v50, 16, v163
v_and_b32 v51, 0xffff0000, v163
v_pk_add_f32 v[46:47], v[46:47], v[50:51]
s_waitcnt vmcnt(11)
v_lshlrev_b32 v48, 16, v164
v_and_b32 v49, 0xffff0000, v164
v_pk_add_f32 v[40:41], v[40:41], v[48:49]
v_lshlrev_b32 v50, 16, v165
v_and_b32 v51, 0xffff0000, v165
v_pk_add_f32 v[42:43], v[42:43], v[50:51]
v_lshlrev_b32 v48, 16, v166
v_and_b32 v49, 0xffff0000, v166
v_pk_add_f32 v[44:45], v[44:45], v[48:49]
v_lshlrev_b32 v50, 16, v167
v_and_b32 v51, 0xffff0000, v167
v_pk_add_f32 v[46:47], v[46:47], v[50:51]
s_waitcnt vmcnt(10)
v_lshlrev_b32 v48, 16, v168
v_and_b32 v49, 0xffff0000, v168
v_pk_add_f32 v[40:41], v[40:41], v[48:49]
v_lshlrev_b32 v50, 16, v169
v_and_b32 v51, 0xffff0000, v169
v_pk_add_f32 v[42:43], v[42:43], v[50:51]
v_lshlrev_b32 v48, 16, v170
v_and_b32 v49, 0xffff0000, v170
v_pk_add_f32 v[44:45], v[44:45], v[48:49]
v_lshlrev_b32 v50, 16, v171
v_and_b32 v51, 0xffff0000, v171
v_pk_add_f32 v[46:47], v[46:47], v[50:51]
s_waitcnt vmcnt(9)
v_lshlrev_b32 v48, 16, v172
v_and_b32 v49, 0xffff0000, v172
v_pk_add_f32 v[40:41], v[40:41], v[48:49]
v_lshlrev_b32 v50, 16, v173
v_and_b32 v51, 0xffff0000, v173
v_pk_add_f32 v[42:43], v[42:43], v[50:51]
v_lshlrev_b32 v48, 16, v174
v_and_b32 v49, 0xffff0000, v174
v_pk_add_f32 v[44:45], v[44:45], v[48:49]
v_lshlrev_b32 v50, 16, v175
v_and_b32 v51, 0xffff0000, v175
v_pk_add_f32 v[46:47], v[46:47], v[50:51]
v_lshlrev_b32 v48, 16, v68
v_and_b32 v49, 0xffff0000, v68
v_pk_add_f32 v[40:41], v[40:41], v[48:49]
v_lshlrev_b32 v50, 16, v69
v_and_b32 v51, 0xffff0000, v69
v_pk_add_f32 v[42:43], v[42:43], v[50:51]
v_lshlrev_b32 v48, 16, v70
v_and_b32 v49, 0xffff0000, v70
v_pk_add_f32 v[44:45], v[44:45], v[48:49]
v_lshlrev_b32 v50, 16, v71
v_and_b32 v51, 0xffff0000, v71
v_pk_add_f32 v[46:47], v[46:47], v[50:51]
v_lshlrev_b32 v48, 16, v196
v_and_b32 v49, 0xffff0000, v196
v_pk_fma_f32 v[40:41], v[40:41], v[24:25], v[48:49]
v_lshlrev_b32 v50, 16, v197
v_and_b32 v51, 0xffff0000, v197
v_pk_fma_f32 v[42:43], v[42:43], v[26:27], v[50:51]
v_lshlrev_b32 v48, 16, v198
v_and_b32 v49, 0xffff0000, v198
v_pk_fma_f32 v[44:45], v[44:45], v[28:29], v[48:49]
v_lshlrev_b32 v50, 16, v199
v_and_b32 v51, 0xffff0000, v199
v_pk_fma_f32 v[46:47], v[46:47], v[30:31], v[50:51]
v_cvt_pk_bf16_f32 v56, v40, v41
v_cvt_pk_bf16_f32 v57, v42, v43
v_cvt_pk_bf16_f32 v58, v44, v45
v_cvt_pk_bf16_f32 v59, v46, v47
buffer_store_dwordx4 v[56:59], v212, s[60:63], s73 offen
s_waitcnt vmcnt(8)
v_lshlrev_b32 v40, 16, v96
v_and_b32 v41, 0xffff0000, v96
v_lshlrev_b32 v42, 16, v97
v_and_b32 v43, 0xffff0000, v97
v_lshlrev_b32 v44, 16, v98
v_and_b32 v45, 0xffff0000, v98
v_lshlrev_b32 v46, 16, v99
v_and_b32 v47, 0xffff0000, v99
s_waitcnt vmcnt(7)
v_lshlrev_b32 v48, 16, v100
v_and_b32 v49, 0xffff0000, v100
v_pk_add_f32 v[40:41], v[40:41], v[48:49]
v_lshlrev_b32 v50, 16, v101
v_and_b32 v51, 0xffff0000, v101
v_pk_add_f32 v[42:43], v[42:43], v[50:51]
v_lshlrev_b32 v48, 16, v102
v_and_b32 v49, 0xffff0000, v102
v_pk_add_f32 v[44:45], v[44:45], v[48:49]
v_lshlrev_b32 v50, 16, v103
v_and_b32 v51, 0xffff0000, v103
v_pk_add_f32 v[46:47], v[46:47], v[50:51]
s_waitcnt vmcnt(6)
v_lshlrev_b32 v48, 16, v104
v_and_b32 v49, 0xffff0000, v104
v_pk_add_f32 v[40:41], v[40:41], v[48:49]
v_lshlrev_b32 v50, 16, v105
v_and_b32 v51, 0xffff0000, v105
v_pk_add_f32 v[42:43], v[42:43], v[50:51]
v_lshlrev_b32 v48, 16, v106
v_and_b32 v49, 0xffff0000, v106
v_pk_add_f32 v[44:45], v[44:45], v[48:49]
v_lshlrev_b32 v50, 16, v107
v_and_b32 v51, 0xffff0000, v107
v_pk_add_f32 v[46:47], v[46:47], v[50:51]
s_waitcnt vmcnt(5)
v_lshlrev_b32 v48, 16, v108
v_and_b32 v49, 0xffff0000, v108
v_pk_add_f32 v[40:41], v[40:41], v[48:49]
v_lshlrev_b32 v50, 16, v109
v_and_b32 v51, 0xffff0000, v109
v_pk_add_f32 v[42:43], v[42:43], v[50:51]
v_lshlrev_b32 v48, 16, v110
v_and_b32 v49, 0xffff0000, v110
v_pk_add_f32 v[44:45], v[44:45], v[48:49]
v_lshlrev_b32 v50, 16, v111
v_and_b32 v51, 0xffff0000, v111
v_pk_add_f32 v[46:47], v[46:47], v[50:51]
s_waitcnt vmcnt(4)
v_lshlrev_b32 v48, 16, v112
v_and_b32 v49, 0xffff0000, v112
v_pk_add_f32 v[40:41], v[40:41], v[48:49]
v_lshlrev_b32 v50, 16, v113
v_and_b32 v51, 0xffff0000, v113
v_pk_add_f32 v[42:43], v[42:43], v[50:51]
v_lshlrev_b32 v48, 16, v114
v_and_b32 v49, 0xffff0000, v114
v_pk_add_f32 v[44:45], v[44:45], v[48:49]
v_lshlrev_b32 v50, 16, v115
v_and_b32 v51, 0xffff0000, v115
v_pk_add_f32 v[46:47], v[46:47], v[50:51]
s_waitcnt vmcnt(3)
v_lshlrev_b32 v48, 16, v116
v_and_b32 v49, 0xffff0000, v116
v_pk_add_f32 v[40:41], v[40:41], v[48:49]
v_lshlrev_b32 v50, 16, v117
v_and_b32 v51, 0xffff0000, v117
v_pk_add_f32 v[42:43], v[42:43], v[50:51]
v_lshlrev_b32 v48, 16, v118
v_and_b32 v49, 0xffff0000, v118
v_pk_add_f32 v[44:45], v[44:45], v[48:49]
v_lshlrev_b32 v50, 16, v119
v_and_b32 v51, 0xffff0000, v119
v_pk_add_f32 v[46:47], v[46:47], v[50:51]
s_waitcnt vmcnt(2)
v_lshlrev_b32 v48, 16, v176
v_and_b32 v49, 0xffff0000, v176
v_pk_add_f32 v[40:41], v[40:41], v[48:49]
v_lshlrev_b32 v50, 16, v177
v_and_b32 v51, 0xffff0000, v177
v_pk_add_f32 v[42:43], v[42:43], v[50:51]
v_lshlrev_b32 v48, 16, v178
v_and_b32 v49, 0xffff0000, v178
v_pk_add_f32 v[44:45], v[44:45], v[48:49]
v_lshlrev_b32 v50, 16, v179
v_and_b32 v51, 0xffff0000, v179
v_pk_add_f32 v[46:47], v[46:47], v[50:51]
s_waitcnt vmcnt(1)
v_lshlrev_b32 v48, 16, v180
v_and_b32 v49, 0xffff0000, v180
v_pk_add_f32 v[40:41], v[40:41], v[48:49]
v_lshlrev_b32 v50, 16, v181
v_and_b32 v51, 0xffff0000, v181
v_pk_add_f32 v[42:43], v[42:43], v[50:51]
v_lshlrev_b32 v48, 16, v182
v_and_b32 v49, 0xffff0000, v182
v_pk_add_f32 v[44:45], v[44:45], v[48:49]
v_lshlrev_b32 v50, 16, v183
v_and_b32 v51, 0xffff0000, v183
v_pk_add_f32 v[46:47], v[46:47], v[50:51]
v_lshlrev_b32 v48, 16, v72
v_and_b32 v49, 0xffff0000, v72
v_pk_add_f32 v[40:41], v[40:41], v[48:49]
v_lshlrev_b32 v50, 16, v73
v_and_b32 v51, 0xffff0000, v73
v_pk_add_f32 v[42:43], v[42:43], v[50:51]
v_lshlrev_b32 v48, 16, v74
v_and_b32 v49, 0xffff0000, v74
v_pk_add_f32 v[44:45], v[44:45], v[48:49]
v_lshlrev_b32 v50, 16, v75
v_and_b32 v51, 0xffff0000, v75
v_pk_add_f32 v[46:47], v[46:47], v[50:51]
v_lshlrev_b32 v48, 16, v200
v_and_b32 v49, 0xffff0000, v200
v_pk_fma_f32 v[40:41], v[40:41], v[32:33], v[48:49]
v_lshlrev_b32 v50, 16, v201
v_and_b32 v51, 0xffff0000, v201
v_pk_fma_f32 v[42:43], v[42:43], v[34:35], v[50:51]
v_lshlrev_b32 v48, 16, v202
v_and_b32 v49, 0xffff0000, v202
v_pk_fma_f32 v[44:45], v[44:45], v[36:37], v[48:49]
v_lshlrev_b32 v50, 16, v203
v_and_b32 v51, 0xffff0000, v203
v_pk_fma_f32 v[46:47], v[46:47], v[38:39], v[50:51]
v_cvt_pk_bf16_f32 v60, v40, v41
v_cvt_pk_bf16_f32 v61, v42, v43
v_cvt_pk_bf16_f32 v62, v44, v45
v_cvt_pk_bf16_f32 v63, v46, v47
buffer_store_dwordx4 v[60:63], v212, s[60:63], s74 offen
ffn_kernel_done:
s_endpgm

.section .rodata,"a"
.p2align 6
.amdhsa_kernel front_kernel
  .amdhsa_next_free_vgpr 192
  .amdhsa_next_free_sgpr 102
  .amdhsa_accum_offset 192
  .amdhsa_group_segment_fixed_size 0
  .amdhsa_kernarg_size 120
  .amdhsa_user_sgpr_count 2
  .amdhsa_user_sgpr_kernarg_segment_ptr 1
  .amdhsa_system_sgpr_workgroup_id_x 1
  .amdhsa_float_denorm_mode_32 3
.end_amdhsa_kernel
.section .rodata,"a"
.p2align 6
.amdhsa_kernel ffn_kernel
  .amdhsa_next_free_vgpr 512
  .amdhsa_next_free_sgpr 102
  .amdhsa_accum_offset 256
  .amdhsa_group_segment_fixed_size 0
  .amdhsa_kernarg_size 120
  .amdhsa_user_sgpr_count 2
  .amdhsa_user_sgpr_kernarg_segment_ptr 1
  .amdhsa_system_sgpr_workgroup_id_x 1
  .amdhsa_float_denorm_mode_32 3
.end_amdhsa_kernel
```
